```python
import torch

def _softmax(x, axis=-1):
    return torch.softmax(x, dim=axis)
def _gelu(x):
    return torch.nn.functional.gelu(x, approximate="tanh")
def _silu(x):
    return torch.nn.functional.silu(x)
def _sigmoid(x):
    return torch.sigmoid(x)
def _layernorm(x, axis=-1, eps=1e-5):
    m = x.mean(dim=axis, keepdim=True)
    v = x.var(dim=axis, keepdim=True, unbiased=False)
    return (x - m) / torch.sqrt(v + eps)
def _scatter_add(tgt, idx, src, axis=0):
    return tgt.clone().index_add_(axis, idx, src)
def _segment_sum(src, seg, n):
    out = torch.zeros((n,) + src.shape[1:], dtype=src.dtype)
    return out.index_add_(0, seg, src)
def _pad(x, pw):
    flat = tuple(v for pair in reversed(pw) for v in pair)
    return torch.nn.functional.pad(x, flat)

kernel_name = 'standalone__gqa_softmax__near_ridge'

def setup_inputs():

    _w = (lambda a: (lambda t: t.to(torch.bfloat16) if t.is_floating_point() else t)(torch.as_tensor(a)))
    B, Hq, Hkv, Sq, Sk, D = 8, 16, 8, 192, 1024, 256
    return {
        "q": _w((lambda *s: torch.randn(*s, dtype=torch.bfloat16) * 0.8)(B, Hq, Sq, D)),
        "k": _w((lambda *s: torch.randn(*s, dtype=torch.bfloat16) * 0.8)(B, Hkv, Sk, D)),
        "v": _w((lambda *s: torch.randn(*s, dtype=torch.bfloat16) * 0.05)(B, Hkv, Sk, D)),
    }

def reference(q, k, v):
    B, Hq, Sq, D = q.shape
    Hkv = k.shape[1]
    rep = Hq // Hkv
    k = (lambda x, n, axis: torch.repeat_interleave(x, n, dim=axis))(k, rep, axis=1)
    v = (lambda x, n, axis: torch.repeat_interleave(x, n, dim=axis))(v, rep, axis=1)
    scale = D ** -0.5
    scores = torch.einsum("bhqd,bhkd->bhqk", q, k) * scale
    p = _softmax(scores, axis=-1)
    return torch.einsum("bhqk,bhkd->bhqd", p, v)
```

```asm
; @launch grid=(256,1,1) block=(256,1,1) lds=163840
.amdgcn_target "amdgcn-amd-amdhsa--gfx950"
.text
.globl standalone__gqa_softmax__near_ridge_kernel
.p2align 12
.p2align 8
.type standalone__gqa_softmax__near_ridge_kernel,@function
.set CODE_SPAN, 31000
standalone__gqa_softmax__near_ridge_kernel:
    s_mov_b32 s30, 0
    v_mov_b32 v20, 0x7f800000
    v_mov_b32 v21, 0x7f800000
    v_mov_b32 v22, 0x7f800000
    v_mov_b32 v23, 0x7f800000
    v_mov_b32 v24, 0x7f800000
    v_mov_b32 v25, 0x7f800000
L_restart:
    s_load_dwordx4 s[4:7], s[0:1], 0
    s_load_dwordx4 s[12:15], s[0:1], 16
    s_cmp_ge_u32 s2, 256
    s_cbranch_scc1 L_end
    v_and_b32 v36, 63, v0
    v_lshrrev_b32 v19, 6, v0
    s_getpc_b64 s[42:43]
    s_lshr_b32 s32, s2, 3
    s_lshl_b32 s32, s32, 11
    v_lshl_add_u32 v144, v0, 7, s32
    v_min_u32 v144, CODE_SPAN, v144
    v_cmp_gt_u32 vcc, 16, v0
    s_and_saveexec_b64 s[18:19], vcc
    s_cbranch_execz L_nopf
    global_load_dword v145, v144, s[42:43]
    L_nopf:
    s_mov_b64 exec, s[18:19]
    s_and_b32 s32, s2, 7
    v_readfirstlane_b32 s20, v19
    s_lshl_b32 s32, s32, 3
    s_lshr_b32 s33, s2, 5
    s_add_u32 s32, s32, s33
    s_bfe_u32 s38, s2, 0x20003
    s_lshl_b32 s34, s32, 2
    s_add_u32 s34, s34, s38
    s_mul_i32 s34, s34, 49152
    s_lshl_b32 s35, s32, 19
    s_add_u32 s88, s2, s33
    s_lshl_b32 s88, s88, 16
    s_and_b32 s88, s88, 0x70000
    s_xor_b32 s96, s38, 0
    s_lshl_b32 s96, s96, 12
    s_xor_b32 s97, s38, 1
    s_lshl_b32 s97, s97, 12
    s_xor_b32 s98, s38, 2
    s_lshl_b32 s98, s98, 12
    s_xor_b32 s99, s38, 3
    s_lshl_b32 s99, s99, 12
    v_lshrrev_b32 v143, 5, v36
    v_lshlrev_b32 v140, 1, v143
    s_lshl_b32 s21, s20, 15
    v_xor_b32 v140, v36, v140
    s_lshl_b32 s37, s20, 14
    v_lshl_add_u32 v11, v140, 4, s37
    v_xor_b32 v12, 64, v11
    v_xor_b32 v13, 128, v11
    v_xor_b32 v14, 192, v11
    s_lshl_b32 s36, s20, 12
    v_lshl_add_u32 v128, v140, 4, s36
    v_xor_b32 v129, 64, v128
    v_xor_b32 v130, 128, v128
    v_xor_b32 v131, 192, v128
    s_waitcnt lgkmcnt(0)
    s_add_u32 s8, s6, s35
    s_addc_u32 s9, s7, 0
    s_add_u32 s4, s4, s34
    s_addc_u32 s5, s5, 0
    s_mov_b32 s6, 49152
    s_mov_b32 s7, 0x20000
    s_mov_b32 s10, 524288
    s_mov_b32 s11, 0x20000
    s_add_u32 m0, s21, 0
    s_add_u32 s22, s96, s88
    buffer_load_dwordx4 v11, s[8:11], s22 offen lds
    buffer_load_dwordx4 v12, s[8:11], s22 offen offset:1024 lds
    buffer_load_dwordx4 v13, s[8:11], s22 offen offset:2048 lds
    buffer_load_dwordx4 v14, s[8:11], s22 offen offset:3072 lds
    s_add_u32 m0, s21, 4096
    s_add_u32 s22, s97, s88
    buffer_load_dwordx4 v11, s[8:11], s22 offen lds
    buffer_load_dwordx4 v12, s[8:11], s22 offen offset:1024 lds
    buffer_load_dwordx4 v13, s[8:11], s22 offen offset:2048 lds
    buffer_load_dwordx4 v14, s[8:11], s22 offen offset:3072 lds
    s_add_u32 m0, s36, 147456
    s_mov_b32 s22, 0
    buffer_load_dwordx4 v128, s[4:7], s22 offen nt lds
    buffer_load_dwordx4 v129, s[4:7], s22 offen offset:1024 nt lds
    buffer_load_dwordx4 v130, s[4:7], s22 offen offset:2048 nt lds
    v_lshrrev_b32 v140, 3, v36
    v_and_b32 v141, 7, v36
    v_lshrrev_b32 v142, 4, v36
    v_and_b32 v139, 15, v36
    v_lshlrev_b32 v19, 1, v141
    v_xor_b32 v19, v142, v19
    v_lshlrev_b32 v19, 4, v19
    v_lshl_add_u32 v32, v139, 9, v19
    v_add_u32 v1, s21, v32
    v_add_u32 v112, 131072, v32
    v_lshl_add_u32 v19, v141, 9, v19
    v_bfe_u32 v32, v36, 3, 1
    v_lshl_add_u32 v116, v32, 15, v19
    v_add_u32 v120, 65536, v116
    v_xor_b32 v2, 64, v1
    v_xor_b32 v113, 64, v112
    v_xor_b32 v117, 64, v116
    v_xor_b32 v121, 64, v120
    v_xor_b32 v35, 128, v1
    v_xor_b32 v114, 128, v112
    v_xor_b32 v118, 128, v116
    v_xor_b32 v122, 128, v120
    v_xor_b32 v39, 192, v1
    v_xor_b32 v115, 192, v112
    v_xor_b32 v119, 192, v116
    v_xor_b32 v123, 192, v120
    s_add_u32 s16, s14, s34
    s_addc_u32 s17, s15, 0
    s_add_u32 s12, s12, s35
    s_addc_u32 s13, s13, 0
    s_sub_u32 s12, s12, 4096
    s_subb_u32 s13, s13, 0
    s_mov_b32 s14, 528384
    s_mov_b32 s15, 0x20000
    s_mov_b32 s18, 49152
    s_mov_b32 s19, 0x20000
    s_add_u32 s89, s88, 65536
    s_and_b32 s89, s89, 0x70000
    s_add_u32 s90, s88, 131072
    s_and_b32 s90, s90, 0x70000
    s_add_u32 s91, s88, 196608
    s_and_b32 s91, s91, 0x70000
    s_add_u32 s92, s88, 262144
    s_and_b32 s92, s92, 0x70000
    s_add_u32 s93, s88, 327680
    s_and_b32 s93, s93, 0x70000
    s_add_u32 s94, s88, 393216
    s_and_b32 s94, s94, 0x70000
    s_add_u32 s95, s88, 458752
    s_and_b32 s95, s95, 0x70000
    s_add_u32 s37, s20, s38
    s_and_b32 s37, s37, 3
    s_lshl_b32 s37, s37, 7
    v_lshlrev_b32 v19, 1, v142
    v_xor_b32 v19, v141, v19
    v_lshlrev_b32 v19, 4, v19
    v_lshl_add_u32 v15, v140, 9, v19
    v_add_u32 v19, s37, v15
    s_add_u32 s32, s96, 4096
    v_add_u32 v15, s32, v19
    s_add_u32 s32, s97, 3072
    v_add_u32 v16, s32, v19
    s_add_u32 s32, s98, 2048
    v_add_u32 v17, s32, v19
    s_add_u32 s32, s99, 1024
    v_add_u32 v18, s32, v19
    s_add_u32 s23, s20, 0
    s_and_b32 s23, s23, 3
    s_mul_i32 s32, s23, 6144
    s_add_u32 s32, s32, 131072
    v_lshl_add_u32 v7, v36, 4, s32
    s_lshl_b32 s23, s23, 14
    s_add_u32 s24, s20, 1
    s_and_b32 s24, s24, 3
    s_mul_i32 s32, s24, 6144
    s_add_u32 s32, s32, 131072
    v_lshl_add_u32 v8, v36, 4, s32
    s_lshl_b32 s24, s24, 14
    s_add_u32 s25, s20, 2
    s_and_b32 s25, s25, 3
    s_mul_i32 s32, s25, 6144
    s_add_u32 s32, s32, 131072
    v_lshl_add_u32 v9, v36, 4, s32
    s_lshl_b32 s25, s25, 14
    s_add_u32 s26, s20, 3
    s_and_b32 s26, s26, 3
    s_mul_i32 s32, s26, 6144
    s_add_u32 s32, s32, 131072
    v_lshl_add_u32 v10, v36, 4, s32
    s_lshl_b32 s26, s26, 14
    v_lshrrev_b32 v19, 2, v36
    v_lshlrev_b32 v19, 7, v19
    v_bfe_u32 v141, v36, 3, 2
    v_lshl_add_u32 v19, v141, 5, v19
    v_and_b32 v141, 3, v36
    v_lshl_add_u32 v19, v141, 3, v19
    v_add_u32 v3, s21, v19
    v_xor_b32 v4, 32, v3
    v_xor_b32 v5, 64, v3
    v_xor_b32 v6, 96, v3
    v_lshrrev_b32 v143, 5, v36
    v_lshl_add_u32 v140, v143, 4, v139
    v_lshlrev_b32 v34, 5, v140
    v_add_u32 v34, 155648, v34
    s_lshl_b32 s32, s20, 1
    v_lshrrev_b32 v33, 1, v140
    v_and_b32 v33, 6, v33
    v_and_b32 v141, 1, v142
    v_xor_b32 v33, v141, v33
    v_xor_b32 v33, s32, v33
    v_lshl_add_u32 v33, v33, 2, v34
    s_mov_b32 s27, 0x3db8aa3b
    s_mov_b32 s29, 0xbdb8aa3b
    s_mov_b32 s28, 0x49800000
    s_mov_b64 exec, 0
    s_cmp_eq_u32 s20, 1
    s_cbranch_scc1 L_iw1
    s_cmp_eq_u32 s20, 2
    s_cbranch_scc1 L_iw2
    s_cmp_eq_u32 s20, 3
    s_cbranch_scc1 L_iw3
    s_branch L_iw0
    L_iwdone:
    s_mov_b64 exec, -1
    buffer_load_dwordx4 v131, s[4:7], s22 offen offset:3072 nt lds
    s_add_u32 m0, s21, 8192
    s_add_u32 s22, s98, s88
    buffer_load_dwordx4 v11, s[8:11], s22 offen lds
    buffer_load_dwordx4 v12, s[8:11], s22 offen offset:1024 lds
    buffer_load_dwordx4 v13, s[8:11], s22 offen offset:2048 lds
    buffer_load_dwordx4 v14, s[8:11], s22 offen offset:3072 lds
    s_add_u32 m0, s21, 12288
    s_add_u32 s22, s99, s88
    buffer_load_dwordx4 v11, s[8:11], s22 offen lds
    buffer_load_dwordx4 v12, s[8:11], s22 offen offset:1024 lds
    buffer_load_dwordx4 v13, s[8:11], s22 offen offset:2048 lds
    s_waitcnt vmcnt(11)
    ds_read_b128 a[192:195], v1 offset:0
    ds_read_b128 a[196:199], v2 offset:0
    ds_read_b128 a[200:203], v35 offset:0
    ds_read_b128 a[204:207], v39 offset:0
    ds_read_b128 a[208:211], v1 offset:256
    ds_read_b128 a[212:215], v2 offset:256
    ds_read_b128 a[216:219], v35 offset:256
    ds_read_b128 a[220:223], v39 offset:256
    buffer_load_dwordx4 v14, s[8:11], s22 offen offset:3072 lds
    s_add_u32 m0, s36, 131072
    s_mov_b32 s22, 16384
    buffer_load_dwordx4 v128, s[4:7], s22 offen nt lds
    buffer_load_dwordx4 v129, s[4:7], s22 offen offset:1024 nt lds
    buffer_load_dwordx4 v130, s[4:7], s22 offen offset:2048 nt lds
    s_waitcnt vmcnt(11)
    s_barrier
    ds_read_b128 a[0:3], v112 offset:16384
    ds_read_b128 a[4:7], v113 offset:16384
    ds_read_b128 a[8:11], v114 offset:16384
    ds_read_b128 a[12:15], v115 offset:16384
    ds_read_b128 a[16:19], v112 offset:16640
    ds_read_b128 a[20:23], v113 offset:16640
    ds_read_b128 a[24:27], v114 offset:16640
    ds_read_b128 a[28:31], v115 offset:16640
    s_waitcnt lgkmcnt(7)
    v_mfma_f32_16x16x32_bf16 v[64:67], a[192:195], a[0:3], 0
    s_waitcnt lgkmcnt(6)
    ds_read_b128 a[32:35], v112 offset:24576
    ds_read_b128 a[36:39], v113 offset:24576
    v_mfma_f32_16x16x32_bf16 v[64:67], a[196:199], a[4:7], v[64:67]
    s_waitcnt lgkmcnt(7)
    ds_read_b128 a[40:43], v114 offset:24576
    ds_read_b128 a[44:47], v115 offset:24576
    v_mfma_f32_16x16x32_bf16 v[64:67], a[200:203], a[8:11], v[64:67]
    s_waitcnt lgkmcnt(8)
    ds_read_b128 a[48:51], v112 offset:24832
    ds_read_b128 a[52:55], v113 offset:24832
    v_mfma_f32_16x16x32_bf16 v[64:67], a[204:207], a[12:15], v[64:67]
    s_waitcnt lgkmcnt(9)
    ds_read_b128 a[56:59], v114 offset:24832
    ds_read_b128 a[60:63], v115 offset:24832
    v_mfma_f32_16x16x32_bf16 v[64:67], a[208:211], a[16:19], v[64:67]
    s_waitcnt lgkmcnt(10)
    v_mfma_f32_16x16x32_bf16 v[64:67], a[212:215], a[20:23], v[64:67]
    buffer_load_dwordx4 v131, s[4:7], s22 offen offset:3072 nt lds
    s_add_u32 m0, s21, 0
    s_mov_b32 s22, 32768
    buffer_load_dwordx4 v128, s[4:7], s22 offen nt lds
    buffer_load_dwordx4 v129, s[4:7], s22 offen offset:1024 nt lds
    buffer_load_dwordx4 v130, s[4:7], s22 offen offset:2048 nt lds
    buffer_load_dwordx4 v131, s[4:7], s22 offen offset:3072 nt lds
    s_add_u32 m0, s21, 16384
    s_add_u32 s22, s96, s89
    buffer_load_dwordx4 v11, s[8:11], s22 offen lds
    buffer_load_dwordx4 v12, s[8:11], s22 offen offset:1024 lds
    buffer_load_dwordx4 v13, s[8:11], s22 offen offset:2048 lds
    s_waitcnt lgkmcnt(9)
    v_mfma_f32_16x16x32_bf16 v[64:67], a[216:219], a[24:27], v[64:67]
    s_waitcnt vmcnt(11) lgkmcnt(8)
    ds_read_b128 a[224:227], v1 offset:8192
    ds_read_b128 a[228:231], v2 offset:8192
    v_mfma_f32_16x16x32_bf16 v[64:67], a[220:223], a[28:31], v[64:67]
    s_waitcnt lgkmcnt(9)
    ds_read_b128 a[232:235], v35 offset:8192
    ds_read_b128 a[236:239], v39 offset:8192
    v_mfma_f32_16x16x32_bf16 v[72:75], a[192:195], a[32:35], 0
    s_waitcnt lgkmcnt(10)
    ds_read_b128 a[240:243], v1 offset:8448
    ds_read_b128 a[244:247], v2 offset:8448
    v_mfma_f32_16x16x32_bf16 v[72:75], a[196:199], a[36:39], v[72:75]
    s_waitcnt lgkmcnt(10)
    ds_read_b128 a[248:251], v35 offset:8448
    ds_read_b128 a[252:255], v39 offset:8448
    v_mfma_f32_16x16x32_bf16 v[72:75], a[200:203], a[40:43], v[72:75]
    v_mfma_f32_16x16x32_bf16 v[72:75], a[204:207], a[44:47], v[72:75]
    s_waitcnt lgkmcnt(8)
    v_mfma_f32_16x16x32_bf16 v[72:75], a[208:211], a[48:51], v[72:75]
    v_mfma_f32_16x16x32_bf16 v[72:75], a[212:215], a[52:55], v[72:75]
    v_mfma_f32_16x16x32_bf16 v[72:75], a[216:219], a[56:59], v[72:75]
    v_mfma_f32_16x16x32_bf16 v[72:75], a[220:223], a[60:63], v[72:75]
    s_waitcnt lgkmcnt(4)
    v_mfma_f32_16x16x32_bf16 v[68:71], a[224:227], a[0:3], 0
    v_mfma_f32_16x16x32_bf16 v[68:71], a[228:231], a[4:7], v[68:71]
    v_mfma_f32_16x16x32_bf16 v[68:71], a[232:235], a[8:11], v[68:71]
    v_mfma_f32_16x16x32_bf16 v[68:71], a[236:239], a[12:15], v[68:71]
    s_waitcnt lgkmcnt(0)
    v_mfma_f32_16x16x32_bf16 v[68:71], a[240:243], a[16:19], v[68:71]
    v_mfma_f32_16x16x32_bf16 v[68:71], a[244:247], a[20:23], v[68:71]
    v_mfma_f32_16x16x32_bf16 v[68:71], a[248:251], a[24:27], v[68:71]
    v_mfma_f32_16x16x32_bf16 v[68:71], a[252:255], a[28:31], v[68:71]
    v_mfma_f32_16x16x32_bf16 v[76:79], a[224:227], a[32:35], 0
    v_mfma_f32_16x16x32_bf16 v[76:79], a[228:231], a[36:39], v[76:79]
    s_barrier
    v_mfma_f32_16x16x32_bf16 v[76:79], a[232:235], a[40:43], v[76:79]
    v_mfma_f32_16x16x32_bf16 v[76:79], a[236:239], a[44:47], v[76:79]
    v_mfma_f32_16x16x32_bf16 v[76:79], a[240:243], a[48:51], v[76:79]
    v_mfma_f32_16x16x32_bf16 v[76:79], a[244:247], a[52:55], v[76:79]
    v_mfma_f32_16x16x32_bf16 v[76:79], a[248:251], a[56:59], v[76:79]
    v_mfma_f32_16x16x32_bf16 v[76:79], a[252:255], a[60:63], v[76:79]
    v_max3_f32 v37, v64, v65, v66
    v_max3_f32 v38, v72, v73, v74
    v_max3_f32 v37, v37, v67, v68
    s_nop 4
    v_max3_f32 v38, v38, v75, v76
    v_max3_f32 v37, v37, v69, v70
    v_max3_f32 v38, v38, v77, v78
    v_max_f32 v37, v37, v71
    v_max_f32 v38, v38, v79
    s_nop 1
    v_permlane32_swap_b32 v37, v38
    v_max_f32 v37, v37, v38
    ds_write_b32 v33, v37 offset:0
    buffer_load_dwordx4 v14, s[8:11], s22 offen offset:3072 lds
    s_add_u32 m0, s21, 20480
    s_add_u32 s22, s97, s89
    buffer_load_dwordx4 v11, s[8:11], s22 offen lds
    buffer_load_dwordx4 v12, s[8:11], s22 offen offset:1024 lds
    buffer_load_dwordx4 v13, s[8:11], s22 offen offset:2048 lds
    s_waitcnt vmcnt(11) lgkmcnt(0)
    s_barrier
    ds_read_b128 a[64:67], v112 offset:0
    ds_read_b128 a[68:71], v113 offset:0
    ds_read_b128 a[72:75], v114 offset:0
    ds_read_b128 a[76:79], v115 offset:0
    ds_read_b128 v[40:43], v34 offset:0
    ds_read_b128 v[44:47], v34 offset:16
    ds_read_b128 a[80:83], v112 offset:256
    ds_read_b128 a[84:87], v113 offset:256
    ds_read_b128 a[88:91], v114 offset:256
    ds_read_b128 a[92:95], v115 offset:256
    s_waitcnt lgkmcnt(9)
    v_mfma_f32_16x16x32_bf16 v[80:83], a[192:195], a[64:67], 0
    s_waitcnt lgkmcnt(8)
    ds_read_b128 a[96:99], v112 offset:8192
    ds_read_b128 a[100:103], v113 offset:8192
    v_mfma_f32_16x16x32_bf16 v[80:83], a[196:199], a[68:71], v[80:83]
    s_waitcnt lgkmcnt(9)
    ds_read_b128 a[104:107], v114 offset:8192
    ds_read_b128 a[108:111], v115 offset:8192
    v_mfma_f32_16x16x32_bf16 v[80:83], a[200:203], a[72:75], v[80:83]
    s_waitcnt lgkmcnt(10)
    ds_read_b128 a[112:115], v112 offset:8448
    ds_read_b128 a[116:119], v113 offset:8448
    v_mfma_f32_16x16x32_bf16 v[80:83], a[204:207], a[76:79], v[80:83]
    s_waitcnt lgkmcnt(9)
    ds_read_b128 a[120:123], v114 offset:8448
    ds_read_b128 a[124:127], v115 offset:8448
    v_mfma_f32_16x16x32_bf16 v[80:83], a[208:211], a[80:83], v[80:83]
    s_waitcnt lgkmcnt(10)
    v_mfma_f32_16x16x32_bf16 v[80:83], a[212:215], a[84:87], v[80:83]
    s_waitcnt lgkmcnt(9)
    v_mfma_f32_16x16x32_bf16 v[80:83], a[216:219], a[88:91], v[80:83]
    s_waitcnt lgkmcnt(8)
    v_mfma_f32_16x16x32_bf16 v[80:83], a[220:223], a[92:95], v[80:83]
    s_waitcnt lgkmcnt(7)
    v_max3_f32 v40, v40, v41, v42
    v_max3_f32 v40, v40, v43, v44
    v_max3_f32 v40, v40, v45, v46
    v_max_f32 v40, v40, v47
    v_mfma_f32_16x16x32_bf16 v[88:91], a[192:195], a[96:99], 0
    s_waitcnt lgkmcnt(6)
    v_mul_f32 v40, s29, v40
    v_mov_b32 v41, v40
    v_mfma_f32_16x16x32_bf16 v[88:91], a[196:199], a[100:103], v[88:91]
    s_waitcnt lgkmcnt(4)
    v_mfma_f32_16x16x32_bf16 v[88:91], a[200:203], a[104:107], v[88:91]
    v_permlane32_swap_b32 v40, v41
    v_mfma_f32_16x16x32_bf16 v[88:91], a[204:207], a[108:111], v[88:91]
    s_waitcnt lgkmcnt(0)
    v_min_f32 v20, v20, v40
    v_min_f32 v21, v21, v41
    v_fma_f32 v64, v64, s27, v20
    v_fma_f32 v65, v65, s27, v20
    v_mfma_f32_16x16x32_bf16 v[88:91], a[208:211], a[112:115], v[88:91]
    v_exp_f32 v64, v64
    v_exp_f32 v65, v65
    v_mfma_f32_16x16x32_bf16 v[88:91], a[212:215], a[116:119], v[88:91]
    v_cvt_pk_bf16_f32 v40, v64, v65
    v_add_f32 v26, v64, v65
    v_fma_f32 v66, v66, s27, v20
    v_fma_f32 v67, v67, s27, v20
    v_mfma_f32_16x16x32_bf16 v[88:91], a[216:219], a[120:123], v[88:91]
    v_exp_f32 v66, v66
    v_exp_f32 v67, v67
    v_mfma_f32_16x16x32_bf16 v[88:91], a[220:223], a[124:127], v[88:91]
    v_cvt_pk_bf16_f32 v41, v66, v67
    v_add_f32 v26, v26, v66
    v_fma_f32 v68, v68, s27, v20
    v_fma_f32 v69, v69, s27, v20
    v_mfma_f32_16x16x32_bf16 v[84:87], a[224:227], a[64:67], 0
    v_exp_f32 v68, v68
    v_exp_f32 v69, v69
    v_mfma_f32_16x16x32_bf16 v[84:87], a[228:231], a[68:71], v[84:87]
    v_cvt_pk_bf16_f32 v42, v68, v69
    v_add_f32 v26, v26, v67
    v_fma_f32 v70, v70, s27, v20
    v_fma_f32 v71, v71, s27, v20
    v_mfma_f32_16x16x32_bf16 v[84:87], a[232:235], a[72:75], v[84:87]
    v_exp_f32 v70, v70
    v_add_f32 v26, v26, v68
    v_fma_f32 v72, v72, s27, v21
    v_mfma_f32_16x16x32_bf16 v[84:87], a[236:239], a[76:79], v[84:87]
    v_exp_f32 v71, v71
    v_add_f32 v26, v26, v69
    v_fma_f32 v73, v73, s27, v21
    v_mfma_f32_16x16x32_bf16 v[84:87], a[240:243], a[80:83], v[84:87]
    v_exp_f32 v72, v72
    v_exp_f32 v73, v73
    v_mfma_f32_16x16x32_bf16 v[84:87], a[244:247], a[84:87], v[84:87]
    v_cvt_pk_bf16_f32 v43, v70, v71
    v_cvt_pk_bf16_f32 v44, v72, v73
    v_add_f32 v26, v26, v70
    v_fma_f32 v74, v74, s27, v21
    v_mfma_f32_16x16x32_bf16 v[84:87], a[248:251], a[88:91], v[84:87]
    v_exp_f32 v74, v74
    v_add_f32 v26, v26, v71
    v_add_f32 v27, v72, v73
    v_mfma_f32_16x16x32_bf16 v[84:87], a[252:255], a[92:95], v[84:87]
    v_add_f32 v27, v27, v74
    v_fma_f32 v75, v75, s27, v21
    v_fma_f32 v76, v76, s27, v21
    v_fma_f32 v77, v77, s27, v21
    v_mfma_f32_16x16x32_bf16 v[92:95], a[224:227], a[96:99], 0
    v_exp_f32 v75, v75
    v_exp_f32 v76, v76
    v_mfma_f32_16x16x32_bf16 v[92:95], a[228:231], a[100:103], v[92:95]
    v_exp_f32 v77, v77
    v_cvt_pk_bf16_f32 v45, v74, v75
    v_add_f32 v27, v27, v75
    v_mfma_f32_16x16x32_bf16 v[92:95], a[232:235], a[104:107], v[92:95]
    v_cvt_pk_bf16_f32 v46, v76, v77
    v_add_f32 v27, v27, v76
    v_fma_f32 v78, v78, s27, v21
    v_fma_f32 v79, v79, s27, v21
    v_mfma_f32_16x16x32_bf16 v[92:95], a[236:239], a[108:111], v[92:95]
    v_exp_f32 v78, v78
    v_exp_f32 v79, v79
    v_mfma_f32_16x16x32_bf16 v[92:95], a[240:243], a[112:115], v[92:95]
    v_cvt_pk_bf16_f32 v47, v78, v79
    v_add_f32 v27, v27, v77
    v_mfma_f32_16x16x32_bf16 v[92:95], a[244:247], a[116:119], v[92:95]
    v_add_f32 v27, v27, v78
    v_mfma_f32_16x16x32_bf16 v[92:95], a[248:251], a[120:123], v[92:95]
    v_add_f32 v27, v27, v79
    v_mfma_f32_16x16x32_bf16 v[92:95], a[252:255], a[124:127], v[92:95]
    v_max3_f32 v37, v80, v81, v82
    v_max3_f32 v38, v88, v89, v90
    v_max3_f32 v37, v37, v83, v84
    s_nop 4
    v_max3_f32 v38, v38, v91, v92
    v_max3_f32 v37, v37, v85, v86
    v_max3_f32 v38, v38, v93, v94
    v_max_f32 v37, v37, v87
    v_max_f32 v38, v38, v95
    s_nop 1
    v_permlane32_swap_b32 v37, v38
    v_max_f32 v37, v37, v38
    ds_write_b32 v33, v37 offset:1024
    buffer_load_dwordx4 v14, s[8:11], s22 offen offset:3072 lds
    s_add_u32 m0, s21, 24576
    s_add_u32 s22, s98, s89
    buffer_load_dwordx4 v11, s[8:11], s22 offen lds
    buffer_load_dwordx4 v12, s[8:11], s22 offen offset:1024 lds
    buffer_load_dwordx4 v13, s[8:11], s22 offen offset:2048 lds
    s_waitcnt vmcnt(11) lgkmcnt(0)
    s_barrier
    ds_read_b128 a[128:131], v116 offset:0
    ds_read_b128 a[132:135], v117 offset:0
    ds_read_b128 a[136:139], v118 offset:0
    ds_read_b128 a[140:143], v119 offset:0
    ds_read_b128 v[48:51], v34 offset:1024
    ds_read_b128 v[52:55], v34 offset:1040
    ds_read_b128 a[144:147], v116 offset:256
    ds_read_b128 a[148:151], v117 offset:256
    ds_read_b128 a[152:155], v118 offset:256
    ds_read_b128 a[156:159], v119 offset:256
    s_waitcnt lgkmcnt(9)
    v_mfma_f32_16x16x32_bf16 v[96:99], a[192:195], a[128:131], 0
    s_waitcnt lgkmcnt(8)
    ds_read_b128 a[160:163], v120 offset:0
    ds_read_b128 a[164:167], v121 offset:0
    v_mfma_f32_16x16x32_bf16 v[96:99], a[196:199], a[132:135], v[96:99]
    s_waitcnt lgkmcnt(9)
    ds_read_b128 a[168:171], v122 offset:0
    ds_read_b128 a[172:175], v123 offset:0
    v_mfma_f32_16x16x32_bf16 v[96:99], a[200:203], a[136:139], v[96:99]
    s_waitcnt lgkmcnt(10)
    ds_read_b128 a[176:179], v120 offset:256
    ds_read_b128 a[180:183], v121 offset:256
    v_mfma_f32_16x16x32_bf16 v[96:99], a[204:207], a[140:143], v[96:99]
    s_waitcnt lgkmcnt(9)
    ds_read_b128 a[184:187], v122 offset:256
    ds_read_b128 a[188:191], v123 offset:256
    v_mfma_f32_16x16x32_bf16 v[96:99], a[208:211], a[144:147], v[96:99]
    s_waitcnt lgkmcnt(10)
    v_mfma_f32_16x16x32_bf16 v[96:99], a[212:215], a[148:151], v[96:99]
    s_waitcnt lgkmcnt(9)
    v_mfma_f32_16x16x32_bf16 v[96:99], a[216:219], a[152:155], v[96:99]
L_iw0:
    s_cbranch_execz L_iw4
    s_waitcnt lgkmcnt(8)
    v_mfma_f32_16x16x32_bf16 v[96:99], a[220:223], a[156:159], v[96:99]
    s_waitcnt lgkmcnt(7)
    v_max3_f32 v48, v48, v49, v50
    v_max3_f32 v48, v48, v51, v52
    v_max3_f32 v48, v48, v53, v54
    v_max_f32 v48, v48, v55
    v_mfma_f32_16x16x32_bf16 v[104:107], a[192:195], a[160:163], 0
    s_waitcnt lgkmcnt(6)
    v_mul_f32 v48, s29, v48
    v_mov_b32 v49, v48
    v_mfma_f32_16x16x32_bf16 v[104:107], a[196:199], a[164:167], v[104:107]
    s_waitcnt lgkmcnt(4)
    v_mfma_f32_16x16x32_bf16 v[104:107], a[200:203], a[168:171], v[104:107]
    v_permlane32_swap_b32 v48, v49
    v_mfma_f32_16x16x32_bf16 v[104:107], a[204:207], a[172:175], v[104:107]
    s_waitcnt lgkmcnt(0)
    v_min_f32 v22, v22, v48
    v_min_f32 v23, v23, v49
    v_fma_f32 v80, v80, s27, v22
    v_fma_f32 v81, v81, s27, v22
    v_mfma_f32_16x16x32_bf16 v[104:107], a[208:211], a[176:179], v[104:107]
    v_exp_f32 v80, v80
    v_exp_f32 v81, v81
    v_mfma_f32_16x16x32_bf16 v[104:107], a[212:215], a[180:183], v[104:107]
    v_cvt_pk_bf16_f32 v48, v80, v81
    v_add_f32 v28, v80, v81
    v_fma_f32 v82, v82, s27, v22
    v_fma_f32 v83, v83, s27, v22
    v_mfma_f32_16x16x32_bf16 v[104:107], a[216:219], a[184:187], v[104:107]
    v_exp_f32 v82, v82
    v_exp_f32 v83, v83
    v_mfma_f32_16x16x32_bf16 v[104:107], a[220:223], a[188:191], v[104:107]
    v_cvt_pk_bf16_f32 v49, v82, v83
    v_add_f32 v28, v28, v82
    v_fma_f32 v84, v84, s27, v22
    v_fma_f32 v85, v85, s27, v22
    v_mfma_f32_16x16x32_bf16 v[100:103], a[224:227], a[128:131], 0
    v_exp_f32 v84, v84
    v_exp_f32 v85, v85
    v_mfma_f32_16x16x32_bf16 v[100:103], a[228:231], a[132:135], v[100:103]
    v_cvt_pk_bf16_f32 v50, v84, v85
    v_add_f32 v28, v28, v83
    v_fma_f32 v86, v86, s27, v22
    v_fma_f32 v87, v87, s27, v22
    v_mfma_f32_16x16x32_bf16 v[100:103], a[232:235], a[136:139], v[100:103]
    v_exp_f32 v86, v86
    v_add_f32 v28, v28, v84
    v_fma_f32 v88, v88, s27, v23
    v_mfma_f32_16x16x32_bf16 v[100:103], a[236:239], a[140:143], v[100:103]
    v_exp_f32 v87, v87
    v_add_f32 v28, v28, v85
    v_fma_f32 v89, v89, s27, v23
    v_mfma_f32_16x16x32_bf16 v[100:103], a[240:243], a[144:147], v[100:103]
    v_exp_f32 v88, v88
    v_exp_f32 v89, v89
    v_mfma_f32_16x16x32_bf16 v[100:103], a[244:247], a[148:151], v[100:103]
    v_cvt_pk_bf16_f32 v51, v86, v87
    v_cvt_pk_bf16_f32 v52, v88, v89
    v_add_f32 v28, v28, v86
    v_fma_f32 v90, v90, s27, v23
    v_mfma_f32_16x16x32_bf16 v[100:103], a[248:251], a[152:155], v[100:103]
    v_exp_f32 v90, v90
    v_add_f32 v28, v28, v87
    v_add_f32 v29, v88, v89
    v_mfma_f32_16x16x32_bf16 v[100:103], a[252:255], a[156:159], v[100:103]
    v_add_f32 v29, v29, v90
    v_fma_f32 v91, v91, s27, v23
    v_fma_f32 v92, v92, s27, v23
    v_fma_f32 v93, v93, s27, v23
    v_mfma_f32_16x16x32_bf16 v[108:111], a[224:227], a[160:163], 0
    v_exp_f32 v91, v91
    v_exp_f32 v92, v92
    v_mfma_f32_16x16x32_bf16 v[108:111], a[228:231], a[164:167], v[108:111]
    v_exp_f32 v93, v93
    v_cvt_pk_bf16_f32 v53, v90, v91
    v_add_f32 v29, v29, v91
    v_mfma_f32_16x16x32_bf16 v[108:111], a[232:235], a[168:171], v[108:111]
    v_cvt_pk_bf16_f32 v54, v92, v93
    v_add_f32 v29, v29, v92
    v_fma_f32 v94, v94, s27, v23
    v_fma_f32 v95, v95, s27, v23
    v_mfma_f32_16x16x32_bf16 v[108:111], a[236:239], a[172:175], v[108:111]
    v_exp_f32 v94, v94
    v_exp_f32 v95, v95
    v_mfma_f32_16x16x32_bf16 v[108:111], a[240:243], a[176:179], v[108:111]
    v_cvt_pk_bf16_f32 v55, v94, v95
    v_add_f32 v29, v29, v93
    v_mfma_f32_16x16x32_bf16 v[108:111], a[244:247], a[180:183], v[108:111]
    v_add_f32 v29, v29, v94
    v_mfma_f32_16x16x32_bf16 v[108:111], a[248:251], a[184:187], v[108:111]
    v_add_f32 v29, v29, v95
    v_mfma_f32_16x16x32_bf16 v[108:111], a[252:255], a[188:191], v[108:111]
    v_max3_f32 v37, v96, v97, v98
    v_max3_f32 v38, v104, v105, v106
    v_max3_f32 v37, v37, v99, v100
    s_nop 4
    v_max3_f32 v38, v38, v107, v108
    v_max3_f32 v37, v37, v101, v102
    v_max3_f32 v38, v38, v109, v110
    v_max_f32 v37, v37, v103
    v_max_f32 v38, v38, v111
    s_nop 1
    v_permlane32_swap_b32 v37, v38
    v_max_f32 v37, v37, v38
    ds_write_b32 v33, v37 offset:2048
    buffer_load_dwordx4 v14, s[8:11], s22 offen offset:3072 lds
    s_add_u32 m0, s21, 28672
    s_add_u32 s22, s99, s89
    buffer_load_dwordx4 v11, s[8:11], s22 offen lds
    buffer_load_dwordx4 v12, s[8:11], s22 offen offset:1024 lds
    buffer_load_dwordx4 v13, s[8:11], s22 offen offset:2048 lds
    buffer_load_dwordx4 v14, s[8:11], s22 offen offset:3072 lds
    s_waitcnt vmcnt(8)
    ds_read_b128 a[208:211], v1 offset:16384
    ds_read_b128 a[212:215], v2 offset:16384
    ds_read_b128 a[216:219], v35 offset:16384
    ds_read_b128 a[220:223], v39 offset:16384
    ds_read_b128 a[232:235], v1 offset:16640
    ds_read_b128 a[236:239], v2 offset:16640
    ds_read_b128 a[240:243], v35 offset:16640
    ds_read_b128 a[244:247], v39 offset:16640
    s_waitcnt lgkmcnt(8)
    s_barrier
    ds_read_b128 v[56:59], v34 offset:2048
    ds_read_b128 v[60:63], v34 offset:2064
    s_add_u32 m0, s21, 0
    s_add_u32 s22, s23, s88
    s_waitcnt lgkmcnt(9)
    v_mfma_f32_16x16x32_bf16 v[112:115], a[208:211], a[0:3], 0
    s_waitcnt lgkmcnt(8)
    buffer_load_dwordx4 v15, s[12:15], s22 offen lds
    v_mfma_f32_16x16x32_bf16 v[112:115], a[212:215], a[4:7], v[112:115]
    s_waitcnt lgkmcnt(7)
    v_mfma_f32_16x16x32_bf16 v[112:115], a[216:219], a[8:11], v[112:115]
    s_waitcnt lgkmcnt(6)
    buffer_load_dwordx4 v16, s[12:15], s22 offen offset:1024 lds
    v_mfma_f32_16x16x32_bf16 v[112:115], a[220:223], a[12:15], v[112:115]
    s_waitcnt lgkmcnt(5)
    v_mfma_f32_16x16x32_bf16 v[112:115], a[232:235], a[16:19], v[112:115]
    s_waitcnt lgkmcnt(4)
    buffer_load_dwordx4 v17, s[12:15], s22 offen offset:2048 lds
    v_mfma_f32_16x16x32_bf16 v[112:115], a[236:239], a[20:23], v[112:115]
    s_waitcnt lgkmcnt(3)
    v_mfma_f32_16x16x32_bf16 v[112:115], a[240:243], a[24:27], v[112:115]
    s_waitcnt lgkmcnt(2)
    buffer_load_dwordx4 v18, s[12:15], s22 offen offset:3072 lds
    v_mfma_f32_16x16x32_bf16 v[112:115], a[244:247], a[28:31], v[112:115]
    s_waitcnt lgkmcnt(0)
    v_max3_f32 v56, v56, v57, v58
    v_max3_f32 v56, v56, v59, v60
    v_mfma_f32_16x16x32_bf16 v[120:123], a[208:211], a[32:35], 0
    s_add_u32 m0, s21, 4096
    v_max3_f32 v56, v56, v61, v62
    v_max_f32 v56, v56, v63
    v_mfma_f32_16x16x32_bf16 v[120:123], a[212:215], a[36:39], v[120:123]
    s_add_u32 s22, s24, s88
    v_mul_f32 v56, s29, v56
    v_mov_b32 v57, v56
    v_mfma_f32_16x16x32_bf16 v[120:123], a[216:219], a[40:43], v[120:123]
    buffer_load_dwordx4 v15, s[12:15], s22 offen lds
    v_mfma_f32_16x16x32_bf16 v[120:123], a[220:223], a[44:47], v[120:123]
    v_permlane32_swap_b32 v56, v57
    v_mfma_f32_16x16x32_bf16 v[120:123], a[232:235], a[48:51], v[120:123]
    v_min_f32 v24, v24, v56
    v_min_f32 v25, v25, v57
    v_mfma_f32_16x16x32_bf16 v[120:123], a[236:239], a[52:55], v[120:123]
    v_fma_f32 v96, v96, s27, v24
    v_fma_f32 v97, v97, s27, v24
    v_mfma_f32_16x16x32_bf16 v[120:123], a[240:243], a[56:59], v[120:123]
    buffer_load_dwordx4 v16, s[12:15], s22 offen offset:1024 lds
    v_mfma_f32_16x16x32_bf16 v[120:123], a[244:247], a[60:63], v[120:123]
    v_exp_f32 v96, v96
    v_mfma_f32_16x16x32_bf16 v[128:131], a[208:211], a[64:67], 0
    v_exp_f32 v97, v97
    v_mfma_f32_16x16x32_bf16 v[128:131], a[212:215], a[68:71], v[128:131]
    v_cvt_pk_bf16_f32 v56, v96, v97
    v_add_f32 v30, v96, v97
    v_mfma_f32_16x16x32_bf16 v[128:131], a[216:219], a[72:75], v[128:131]
    buffer_load_dwordx4 v17, s[12:15], s22 offen offset:2048 lds
    v_mfma_f32_16x16x32_bf16 v[128:131], a[220:223], a[76:79], v[128:131]
    v_fma_f32 v98, v98, s27, v24
    v_fma_f32 v99, v99, s27, v24
    v_mfma_f32_16x16x32_bf16 v[128:131], a[232:235], a[80:83], v[128:131]
    v_exp_f32 v98, v98
    v_mfma_f32_16x16x32_bf16 v[128:131], a[236:239], a[84:87], v[128:131]
    v_exp_f32 v99, v99
    v_mfma_f32_16x16x32_bf16 v[128:131], a[240:243], a[88:91], v[128:131]
    buffer_load_dwordx4 v18, s[12:15], s22 offen offset:3072 lds
    v_mfma_f32_16x16x32_bf16 v[128:131], a[244:247], a[92:95], v[128:131]
    v_cvt_pk_bf16_f32 v57, v98, v99
    v_add_f32 v30, v30, v98
    v_mfma_f32_16x16x32_bf16 v[136:139], a[208:211], a[96:99], 0
    s_waitcnt vmcnt(8)
    ds_read_b128 a[248:251], v1 offset:24576
    ds_read_b128 a[252:255], v2 offset:24576
    v_mfma_f32_16x16x32_bf16 v[136:139], a[212:215], a[100:103], v[136:139]
    v_add_f32 v30, v30, v99
    v_fma_f32 v100, v100, s27, v24
    v_mfma_f32_16x16x32_bf16 v[136:139], a[216:219], a[104:107], v[136:139]
    s_add_u32 m0, s21, 16384
    ds_read_b128 a[224:227], v35 offset:24576
    ds_read_b128 a[228:231], v39 offset:24576
    v_mfma_f32_16x16x32_bf16 v[136:139], a[220:223], a[108:111], v[136:139]
    s_add_u32 s22, s96, s90
    v_exp_f32 v100, v100
    v_mfma_f32_16x16x32_bf16 v[136:139], a[232:235], a[112:115], v[136:139]
    buffer_load_dwordx4 v11, s[8:11], s22 offen lds
    v_mfma_f32_16x16x32_bf16 v[136:139], a[236:239], a[116:119], v[136:139]
    ds_write_b128 v7, v[40:43] offset:0
    v_mfma_f32_16x16x32_bf16 v[136:139], a[240:243], a[120:123], v[136:139]
    v_add_f32 v30, v30, v100
    v_fma_f32 v101, v101, s27, v24
    v_mfma_f32_16x16x32_bf16 v[136:139], a[244:247], a[124:127], v[136:139]
    buffer_load_dwordx4 v12, s[8:11], s22 offen offset:1024 lds
    v_mfma_f32_16x16x32_bf16 v[144:147], a[208:211], a[128:131], 0
    v_exp_f32 v101, v101
    v_mfma_f32_16x16x32_bf16 v[144:147], a[212:215], a[132:135], v[144:147]
    ds_write_b128 v7, v[44:47] offset:1024
    v_mfma_f32_16x16x32_bf16 v[144:147], a[216:219], a[136:139], v[144:147]
    buffer_load_dwordx4 v13, s[8:11], s22 offen offset:2048 lds
    v_mfma_f32_16x16x32_bf16 v[144:147], a[220:223], a[140:143], v[144:147]
    v_cvt_pk_bf16_f32 v58, v100, v101
    v_add_f32 v30, v30, v101
    v_mfma_f32_16x16x32_bf16 v[144:147], a[232:235], a[144:147], v[144:147]
    v_fma_f32 v102, v102, s27, v24
    v_fma_f32 v103, v103, s27, v24
    v_mfma_f32_16x16x32_bf16 v[144:147], a[236:239], a[148:151], v[144:147]
    buffer_load_dwordx4 v14, s[8:11], s22 offen offset:3072 lds
    v_mfma_f32_16x16x32_bf16 v[144:147], a[240:243], a[152:155], v[144:147]
    ds_write_b128 v7, v[48:51] offset:2048
    v_mfma_f32_16x16x32_bf16 v[144:147], a[244:247], a[156:159], v[144:147]
    v_exp_f32 v102, v102
    v_mfma_f32_16x16x32_bf16 v[152:155], a[208:211], a[160:163], 0
    v_exp_f32 v103, v103
    v_mfma_f32_16x16x32_bf16 v[152:155], a[212:215], a[164:167], v[152:155]
    ds_read_b128 a[208:211], v1 offset:24832
    ds_read_b128 a[212:215], v2 offset:24832
    v_mfma_f32_16x16x32_bf16 v[152:155], a[216:219], a[168:171], v[152:155]
    ds_write_b128 v7, v[52:55] offset:3072
    v_mfma_f32_16x16x32_bf16 v[152:155], a[220:223], a[172:175], v[152:155]
    ds_read_b128 a[216:219], v35 offset:24832
    ds_read_b128 a[220:223], v39 offset:24832
    v_mfma_f32_16x16x32_bf16 v[152:155], a[232:235], a[176:179], v[152:155]
    v_cvt_pk_bf16_f32 v59, v102, v103
    v_add_f32 v30, v30, v102
    v_mfma_f32_16x16x32_bf16 v[152:155], a[236:239], a[180:183], v[152:155]
    v_add_f32 v30, v30, v103
    v_fma_f32 v104, v104, s27, v25
    v_mfma_f32_16x16x32_bf16 v[152:155], a[240:243], a[184:187], v[152:155]
    ds_write_b128 v7, v[56:59] offset:4096
    v_mfma_f32_16x16x32_bf16 v[152:155], a[244:247], a[188:191], v[152:155]
    s_waitcnt lgkmcnt(9)
    v_exp_f32 v104, v104
    v_mfma_f32_16x16x32_bf16 v[116:119], a[248:251], a[0:3], 0
    v_fma_f32 v105, v105, s27, v25
    v_fma_f32 v106, v106, s27, v25
    v_mfma_f32_16x16x32_bf16 v[116:119], a[252:255], a[4:7], v[116:119]
    v_exp_f32 v105, v105
    v_mfma_f32_16x16x32_bf16 v[116:119], a[224:227], a[8:11], v[116:119]
    v_exp_f32 v106, v106
    v_mfma_f32_16x16x32_bf16 v[116:119], a[228:231], a[12:15], v[116:119]
    s_waitcnt lgkmcnt(4)
    v_cvt_pk_bf16_f32 v60, v104, v105
    v_add_f32 v31, v104, v105
    v_mfma_f32_16x16x32_bf16 v[116:119], a[208:211], a[16:19], v[116:119]
    v_add_f32 v31, v31, v106
    v_fma_f32 v107, v107, s27, v25
    v_mfma_f32_16x16x32_bf16 v[116:119], a[212:215], a[20:23], v[116:119]
    s_waitcnt lgkmcnt(1)
    v_exp_f32 v107, v107
    v_mfma_f32_16x16x32_bf16 v[116:119], a[216:219], a[24:27], v[116:119]
    v_cvt_pk_bf16_f32 v61, v106, v107
    v_add_f32 v31, v31, v107
    v_mfma_f32_16x16x32_bf16 v[116:119], a[220:223], a[28:31], v[116:119]
    v_fma_f32 v108, v108, s27, v25
    v_fma_f32 v109, v109, s27, v25
    v_mfma_f32_16x16x32_bf16 v[124:127], a[248:251], a[32:35], 0
    v_exp_f32 v108, v108
    v_mfma_f32_16x16x32_bf16 v[124:127], a[252:255], a[36:39], v[124:127]
    v_exp_f32 v109, v109
    v_mfma_f32_16x16x32_bf16 v[124:127], a[224:227], a[40:43], v[124:127]
    s_add_u32 m0, s21, 8192
    v_cvt_pk_bf16_f32 v62, v108, v109
    v_add_f32 v31, v31, v108
    v_mfma_f32_16x16x32_bf16 v[124:127], a[228:231], a[44:47], v[124:127]
    s_add_u32 s22, s25, s88
    v_add_f32 v31, v31, v109
    v_fma_f32 v110, v110, s27, v25
    v_mfma_f32_16x16x32_bf16 v[124:127], a[208:211], a[48:51], v[124:127]
    buffer_load_dwordx4 v15, s[12:15], s22 offen lds
    v_mfma_f32_16x16x32_bf16 v[124:127], a[212:215], a[52:55], v[124:127]
    v_exp_f32 v110, v110
    v_mfma_f32_16x16x32_bf16 v[124:127], a[216:219], a[56:59], v[124:127]
    v_add_f32 v31, v31, v110
    v_fma_f32 v111, v111, s27, v25
    v_mfma_f32_16x16x32_bf16 v[124:127], a[220:223], a[60:63], v[124:127]
    v_exp_f32 v111, v111
    v_mfma_f32_16x16x32_bf16 v[132:135], a[248:251], a[64:67], 0
    buffer_load_dwordx4 v16, s[12:15], s22 offen offset:1024 lds
    v_mfma_f32_16x16x32_bf16 v[132:135], a[252:255], a[68:71], v[132:135]
    v_cvt_pk_bf16_f32 v63, v110, v111
    v_add_f32 v31, v31, v111
    v_mfma_f32_16x16x32_bf16 v[132:135], a[224:227], a[72:75], v[132:135]
    ds_write_b128 v7, v[60:63] offset:5120
    v_mfma_f32_16x16x32_bf16 v[132:135], a[228:231], a[76:79], v[132:135]
    v_fma_f32 v112, v112, s27, v20
    v_fma_f32 v113, v113, s27, v20
    v_mfma_f32_16x16x32_bf16 v[132:135], a[208:211], a[80:83], v[132:135]
    buffer_load_dwordx4 v17, s[12:15], s22 offen offset:2048 lds
    v_mfma_f32_16x16x32_bf16 v[132:135], a[212:215], a[84:87], v[132:135]
    v_exp_f32 v112, v112
    v_mfma_f32_16x16x32_bf16 v[132:135], a[216:219], a[88:91], v[132:135]
    v_exp_f32 v113, v113
    v_mfma_f32_16x16x32_bf16 v[132:135], a[220:223], a[92:95], v[132:135]
    v_add_f32 v26, v26, v112
    v_fma_f32 v114, v114, s27, v20
    v_mfma_f32_16x16x32_bf16 v[140:143], a[248:251], a[96:99], 0
    buffer_load_dwordx4 v18, s[12:15], s22 offen offset:3072 lds
    v_mfma_f32_16x16x32_bf16 v[140:143], a[252:255], a[100:103], v[140:143]
    v_exp_f32 v114, v114
    v_mfma_f32_16x16x32_bf16 v[140:143], a[224:227], a[104:107], v[140:143]
    v_add_f32 v26, v26, v113
    v_fma_f32 v115, v115, s27, v20
    v_mfma_f32_16x16x32_bf16 v[140:143], a[228:231], a[108:111], v[140:143]
    v_exp_f32 v115, v115
    v_mfma_f32_16x16x32_bf16 v[140:143], a[208:211], a[112:115], v[140:143]
    s_add_u32 m0, s21, 12288
    v_add_f32 v26, v26, v114
    v_fma_f32 v116, v116, s27, v20
    v_mfma_f32_16x16x32_bf16 v[140:143], a[212:215], a[116:119], v[140:143]
    s_add_u32 s22, s26, s88
    v_exp_f32 v116, v116
    v_mfma_f32_16x16x32_bf16 v[140:143], a[216:219], a[120:123], v[140:143]
    buffer_load_dwordx4 v15, s[12:15], s22 offen lds
    v_mfma_f32_16x16x32_bf16 v[140:143], a[220:223], a[124:127], v[140:143]
    v_add_f32 v26, v26, v115
    v_fma_f32 v117, v117, s27, v20
    v_mfma_f32_16x16x32_bf16 v[148:151], a[248:251], a[128:131], 0
    v_exp_f32 v117, v117
    v_mfma_f32_16x16x32_bf16 v[148:151], a[252:255], a[132:135], v[148:151]
    v_add_f32 v26, v26, v116
    v_fma_f32 v118, v118, s27, v20
    v_mfma_f32_16x16x32_bf16 v[148:151], a[224:227], a[136:139], v[148:151]
    buffer_load_dwordx4 v16, s[12:15], s22 offen offset:1024 lds
    v_mfma_f32_16x16x32_bf16 v[148:151], a[228:231], a[140:143], v[148:151]
    v_exp_f32 v118, v118
    v_mfma_f32_16x16x32_bf16 v[148:151], a[208:211], a[144:147], v[148:151]
    s_waitcnt vmcnt(14)
    ds_read_b64_tr_b16 a[192:193], v3 offset:0
    ds_read_b64_tr_b16 a[194:195], v3 offset:2048
    v_mfma_f32_16x16x32_bf16 v[148:151], a[212:215], a[148:151], v[148:151]
    v_add_f32 v26, v26, v117
    v_fma_f32 v119, v119, s27, v20
    v_mfma_f32_16x16x32_bf16 v[148:151], a[216:219], a[152:155], v[148:151]
    buffer_load_dwordx4 v17, s[12:15], s22 offen offset:2048 lds
    v_mfma_f32_16x16x32_bf16 v[148:151], a[220:223], a[156:159], v[148:151]
    ds_read_b64_tr_b16 a[196:197], v4 offset:0
    ds_read_b64_tr_b16 a[198:199], v4 offset:2048
    v_mfma_f32_16x16x32_bf16 v[156:159], a[248:251], a[160:163], 0
    v_exp_f32 v119, v119
    v_mfma_f32_16x16x32_bf16 v[156:159], a[252:255], a[164:167], v[156:159]
    v_add_f32 v26, v26, v118
    v_fma_f32 v120, v120, s27, v21
    v_mfma_f32_16x16x32_bf16 v[156:159], a[224:227], a[168:171], v[156:159]
    ds_read_b64_tr_b16 a[200:201], v5 offset:0
    ds_read_b64_tr_b16 a[202:203], v5 offset:2048
    v_mfma_f32_16x16x32_bf16 v[156:159], a[228:231], a[172:175], v[156:159]
    buffer_load_dwordx4 v18, s[12:15], s22 offen offset:3072 lds
    v_mfma_f32_16x16x32_bf16 v[156:159], a[208:211], a[176:179], v[156:159]
    v_exp_f32 v120, v120
    v_mfma_f32_16x16x32_bf16 v[156:159], a[212:215], a[180:183], v[156:159]
    s_add_u32 s22, s97, s90
    ds_read_b64_tr_b16 a[204:205], v6 offset:0
    ds_read_b64_tr_b16 a[206:207], v6 offset:2048
    v_mfma_f32_16x16x32_bf16 v[156:159], a[216:219], a[184:187], v[156:159]
    s_add_u32 m0, s21, 20480
    v_add_f32 v26, v26, v119
    v_add_f32 v27, v27, v120
    v_mfma_f32_16x16x32_bf16 v[156:159], a[220:223], a[188:191], v[156:159]
    s_waitcnt lgkmcnt(4)
    v_fma_f32 v121, v121, s27, v21
    v_fma_f32 v122, v122, s27, v21
    v_mfma_f32_16x16x32_bf16 v[160:163], a[192:195], v[40:43], 0
    buffer_load_dwordx4 v11, s[8:11], s22 offen lds
    v_mfma_f32_16x16x32_bf16 v[164:167], a[196:199], v[40:43], 0
    s_waitcnt lgkmcnt(2)
    v_exp_f32 v121, v121
    v_mfma_f32_16x16x32_bf16 v[168:171], a[200:203], v[40:43], 0
    s_waitcnt lgkmcnt(0)
    v_exp_f32 v122, v122
    v_mfma_f32_16x16x32_bf16 v[172:175], a[204:207], v[40:43], 0
    v_cvt_pk_bf16_f32 v40, v112, v113
    v_cvt_pk_bf16_f32 v41, v114, v115
    v_mfma_f32_16x16x32_bf16 v[176:179], a[192:195], v[44:47], 0
    buffer_load_dwordx4 v12, s[8:11], s22 offen offset:1024 lds
    v_mfma_f32_16x16x32_bf16 v[180:183], a[196:199], v[44:47], 0
    v_cvt_pk_bf16_f32 v42, v116, v117
    v_cvt_pk_bf16_f32 v43, v118, v119
    v_mfma_f32_16x16x32_bf16 v[184:187], a[200:203], v[44:47], 0
    v_add_f32 v27, v27, v121
    v_fma_f32 v123, v123, s27, v21
    v_mfma_f32_16x16x32_bf16 v[188:191], a[204:207], v[44:47], 0
    v_exp_f32 v123, v123
    v_mfma_f32_16x16x32_bf16 v[192:195], a[192:195], v[48:51], 0
    buffer_load_dwordx4 v13, s[8:11], s22 offen offset:2048 lds
    v_mfma_f32_16x16x32_bf16 v[196:199], a[196:199], v[48:51], 0
    v_cvt_pk_bf16_f32 v44, v120, v121
    v_cvt_pk_bf16_f32 v45, v122, v123
    v_mfma_f32_16x16x32_bf16 v[200:203], a[200:203], v[48:51], 0
    v_add_f32 v27, v27, v122
    v_fma_f32 v124, v124, s27, v21
    v_mfma_f32_16x16x32_bf16 v[204:207], a[204:207], v[48:51], 0
    v_exp_f32 v124, v124
    v_mfma_f32_16x16x32_bf16 v[208:211], a[192:195], v[52:55], 0
    buffer_load_dwordx4 v14, s[8:11], s22 offen offset:3072 lds
    v_mfma_f32_16x16x32_bf16 v[212:215], a[196:199], v[52:55], 0
    v_add_f32 v27, v27, v123
    v_fma_f32 v125, v125, s27, v21
    v_mfma_f32_16x16x32_bf16 v[216:219], a[200:203], v[52:55], 0
    v_exp_f32 v125, v125
    v_mfma_f32_16x16x32_bf16 v[220:223], a[204:207], v[52:55], 0
    s_add_u32 s22, s23, s89
    s_barrier
    v_mfma_f32_16x16x32_bf16 v[224:227], a[192:195], v[56:59], 0
    s_add_u32 m0, s21, 0
    ds_read_b128 a[224:227], v8 offset:0
    ds_read_b128 a[228:231], v8 offset:1024
    v_mfma_f32_16x16x32_bf16 v[228:231], a[196:199], v[56:59], 0
    s_waitcnt vmcnt(16)
    ds_read_b64_tr_b16 a[208:209], v3 offset:4096
    ds_read_b64_tr_b16 a[210:211], v3 offset:6144
    v_mfma_f32_16x16x32_bf16 v[232:235], a[200:203], v[56:59], 0
    ds_read_b64_tr_b16 a[212:213], v4 offset:4096
    ds_read_b64_tr_b16 a[214:215], v4 offset:6144
    v_mfma_f32_16x16x32_bf16 v[236:239], a[204:207], v[56:59], 0
    ds_read_b64_tr_b16 a[216:217], v5 offset:4096
    ds_read_b64_tr_b16 a[218:219], v5 offset:6144
    v_mfma_f32_16x16x32_bf16 v[240:243], a[192:195], v[60:63], 0
    ds_read_b64_tr_b16 a[220:221], v6 offset:4096
    ds_read_b64_tr_b16 a[222:223], v6 offset:6144
    v_mfma_f32_16x16x32_bf16 v[244:247], a[196:199], v[60:63], 0
    ds_read_b128 a[232:235], v8 offset:2048
    ds_read_b128 a[236:239], v8 offset:3072
    v_mfma_f32_16x16x32_bf16 v[248:251], a[200:203], v[60:63], 0
    buffer_load_dwordx4 v15, s[12:15], s22 offen lds
    v_mfma_f32_16x16x32_bf16 v[252:255], a[204:207], v[60:63], 0
    s_waitcnt lgkmcnt(8)
    buffer_load_dwordx4 v16, s[12:15], s22 offen offset:1024 lds
    v_mfma_f32_16x16x32_bf16 v[160:163], a[208:211], a[224:227], v[160:163]
    s_waitcnt lgkmcnt(6)
    ds_read_b128 a[240:243], v8 offset:4096
    ds_read_b128 a[244:247], v8 offset:5120
    v_mfma_f32_16x16x32_bf16 v[164:167], a[212:215], a[224:227], v[164:167]
    s_waitcnt lgkmcnt(6)
    buffer_load_dwordx4 v17, s[12:15], s22 offen offset:2048 lds
    v_mfma_f32_16x16x32_bf16 v[168:171], a[216:219], a[224:227], v[168:171]
    s_waitcnt vmcnt(11) lgkmcnt(4)
    ds_read_b64_tr_b16 a[192:193], v3 offset:8192
    ds_read_b64_tr_b16 a[194:195], v3 offset:10240
    v_mfma_f32_16x16x32_bf16 v[172:175], a[220:223], a[224:227], v[172:175]
    buffer_load_dwordx4 v18, s[12:15], s22 offen offset:3072 lds
    v_mfma_f32_16x16x32_bf16 v[176:179], a[208:211], a[228:231], v[176:179]
    v_cvt_pk_bf16_f32 v46, v124, v125
    v_add_f32 v27, v27, v124
    v_mfma_f32_16x16x32_bf16 v[180:183], a[212:215], a[228:231], v[180:183]
    v_add_f32 v27, v27, v125
    v_fma_f32 v126, v126, s27, v21
    v_mfma_f32_16x16x32_bf16 v[184:187], a[216:219], a[228:231], v[184:187]
    ds_read_b64_tr_b16 a[196:197], v4 offset:8192
    ds_read_b64_tr_b16 a[198:199], v4 offset:10240
    v_mfma_f32_16x16x32_bf16 v[188:191], a[220:223], a[228:231], v[188:191]
    s_waitcnt lgkmcnt(6)
    v_exp_f32 v126, v126
    v_mfma_f32_16x16x32_bf16 v[192:195], a[208:211], a[232:235], v[192:195]
    s_add_u32 m0, s21, 24576
    ds_read_b128 a[248:251], v9 offset:0
    ds_read_b128 a[252:255], v9 offset:1024
    v_mfma_f32_16x16x32_bf16 v[196:199], a[212:215], a[232:235], v[196:199]
    s_add_u32 s22, s98, s90
    v_add_f32 v27, v27, v126
    v_fma_f32 v127, v127, s27, v21
    v_mfma_f32_16x16x32_bf16 v[200:203], a[216:219], a[232:235], v[200:203]
    ds_read_b64_tr_b16 a[200:201], v5 offset:8192
    ds_read_b64_tr_b16 a[202:203], v5 offset:10240
    v_mfma_f32_16x16x32_bf16 v[204:207], a[220:223], a[232:235], v[204:207]
    buffer_load_dwordx4 v11, s[8:11], s22 offen lds
    v_mfma_f32_16x16x32_bf16 v[208:211], a[208:211], a[236:239], v[208:211]
    v_exp_f32 v127, v127
    v_mfma_f32_16x16x32_bf16 v[212:215], a[212:215], a[236:239], v[212:215]
    v_cvt_pk_bf16_f32 v47, v126, v127
    v_add_f32 v27, v27, v127
    v_mfma_f32_16x16x32_bf16 v[216:219], a[216:219], a[236:239], v[216:219]
    ds_read_b64_tr_b16 a[204:205], v6 offset:8192
    ds_read_b64_tr_b16 a[206:207], v6 offset:10240
    v_mfma_f32_16x16x32_bf16 v[220:223], a[220:223], a[236:239], v[220:223]
    s_waitcnt lgkmcnt(6)
    buffer_load_dwordx4 v12, s[8:11], s22 offen offset:1024 lds
    v_mfma_f32_16x16x32_bf16 v[224:227], a[208:211], a[240:243], v[224:227]
    ds_read_b128 a[224:227], v9 offset:2048
    ds_read_b128 a[228:231], v9 offset:3072
    v_mfma_f32_16x16x32_bf16 v[228:231], a[212:215], a[240:243], v[228:231]
    v_fma_f32 v128, v128, s27, v22
    v_fma_f32 v129, v129, s27, v22
    v_mfma_f32_16x16x32_bf16 v[232:235], a[216:219], a[240:243], v[232:235]
    buffer_load_dwordx4 v13, s[8:11], s22 offen offset:2048 lds
    v_mfma_f32_16x16x32_bf16 v[236:239], a[220:223], a[240:243], v[236:239]
    v_exp_f32 v128, v128
    v_mfma_f32_16x16x32_bf16 v[240:243], a[208:211], a[244:247], v[240:243]
    v_exp_f32 v129, v129
    v_mfma_f32_16x16x32_bf16 v[244:247], a[212:215], a[244:247], v[244:247]
    v_cvt_pk_bf16_f32 v48, v128, v129
    v_add_f32 v28, v28, v128
    v_mfma_f32_16x16x32_bf16 v[248:251], a[216:219], a[244:247], v[248:251]
    buffer_load_dwordx4 v14, s[8:11], s22 offen offset:3072 lds
    v_mfma_f32_16x16x32_bf16 v[252:255], a[220:223], a[244:247], v[252:255]
    s_waitcnt lgkmcnt(2)
    v_add_f32 v28, v28, v129
    v_fma_f32 v130, v130, s27, v22
    v_mfma_f32_16x16x32_bf16 v[160:163], a[192:195], a[248:251], v[160:163]
    ds_read_b128 a[232:235], v9 offset:4096
    ds_read_b128 a[236:239], v9 offset:5120
    v_mfma_f32_16x16x32_bf16 v[164:167], a[196:199], a[248:251], v[164:167]
    s_add_u32 m0, s21, 28672
    v_exp_f32 v130, v130
    v_mfma_f32_16x16x32_bf16 v[168:171], a[200:203], a[248:251], v[168:171]
    s_waitcnt vmcnt(12)
    ds_read_b64_tr_b16 a[208:209], v3 offset:12288
    ds_read_b64_tr_b16 a[210:211], v3 offset:14336
    v_mfma_f32_16x16x32_bf16 v[172:175], a[204:207], a[248:251], v[172:175]
    s_add_u32 s22, s99, s90
    v_add_f32 v28, v28, v130
    v_fma_f32 v131, v131, s27, v22
    v_mfma_f32_16x16x32_bf16 v[176:179], a[192:195], a[252:255], v[176:179]
    buffer_load_dwordx4 v11, s[8:11], s22 offen lds
    v_mfma_f32_16x16x32_bf16 v[180:183], a[196:199], a[252:255], v[180:183]
    v_exp_f32 v131, v131
    v_mfma_f32_16x16x32_bf16 v[184:187], a[200:203], a[252:255], v[184:187]
    ds_read_b64_tr_b16 a[212:213], v4 offset:12288
    ds_read_b64_tr_b16 a[214:215], v4 offset:14336
    v_mfma_f32_16x16x32_bf16 v[188:191], a[204:207], a[252:255], v[188:191]
    s_waitcnt lgkmcnt(6)
    v_cvt_pk_bf16_f32 v49, v130, v131
    v_add_f32 v28, v28, v131
    v_mfma_f32_16x16x32_bf16 v[192:195], a[192:195], a[224:227], v[192:195]
    ds_read_b128 a[240:243], v10 offset:0
    ds_read_b128 a[244:247], v10 offset:1024
    v_mfma_f32_16x16x32_bf16 v[196:199], a[196:199], a[224:227], v[196:199]
    buffer_load_dwordx4 v12, s[8:11], s22 offen offset:1024 lds
    v_mfma_f32_16x16x32_bf16 v[200:203], a[200:203], a[224:227], v[200:203]
    ds_read_b64_tr_b16 a[216:217], v5 offset:12288
    ds_read_b64_tr_b16 a[218:219], v5 offset:14336
    v_mfma_f32_16x16x32_bf16 v[204:207], a[204:207], a[224:227], v[204:207]
    v_fma_f32 v132, v132, s27, v22
    v_fma_f32 v133, v133, s27, v22
    v_mfma_f32_16x16x32_bf16 v[208:211], a[192:195], a[228:231], v[208:211]
    buffer_load_dwordx4 v13, s[8:11], s22 offen offset:2048 lds
    v_mfma_f32_16x16x32_bf16 v[212:215], a[196:199], a[228:231], v[212:215]
    v_exp_f32 v132, v132
    v_mfma_f32_16x16x32_bf16 v[216:219], a[200:203], a[228:231], v[216:219]
    ds_read_b64_tr_b16 a[220:221], v6 offset:12288
    ds_read_b64_tr_b16 a[222:223], v6 offset:14336
    v_mfma_f32_16x16x32_bf16 v[220:223], a[204:207], a[228:231], v[220:223]
    s_waitcnt lgkmcnt(6)
    v_exp_f32 v133, v133
    v_mfma_f32_16x16x32_bf16 v[224:227], a[192:195], a[232:235], v[224:227]
    ds_read_b128 a[248:251], v10 offset:2048
    ds_read_b128 a[252:255], v10 offset:3072
    v_mfma_f32_16x16x32_bf16 v[228:231], a[196:199], a[232:235], v[228:231]
    buffer_load_dwordx4 v14, s[8:11], s22 offen offset:3072 lds
    v_mfma_f32_16x16x32_bf16 v[232:235], a[200:203], a[232:235], v[232:235]
    v_cvt_pk_bf16_f32 v50, v132, v133
    v_add_f32 v28, v28, v132
    v_mfma_f32_16x16x32_bf16 v[236:239], a[204:207], a[232:235], v[236:239]
    v_add_f32 v28, v28, v133
    v_fma_f32 v134, v134, s27, v22
    v_mfma_f32_16x16x32_bf16 v[240:243], a[192:195], a[236:239], v[240:243]
    v_exp_f32 v134, v134
    v_mfma_f32_16x16x32_bf16 v[244:247], a[196:199], a[236:239], v[244:247]
    v_add_f32 v28, v28, v134
    v_fma_f32 v135, v135, s27, v22
    v_mfma_f32_16x16x32_bf16 v[248:251], a[200:203], a[236:239], v[248:251]
    v_exp_f32 v135, v135
    v_mfma_f32_16x16x32_bf16 v[252:255], a[204:207], a[236:239], v[252:255]
    s_waitcnt lgkmcnt(2)
    v_cvt_pk_bf16_f32 v51, v134, v135
    v_add_f32 v28, v28, v135
    v_mfma_f32_16x16x32_bf16 v[160:163], a[208:211], a[240:243], v[160:163]
    ds_read_b128 a[224:227], v10 offset:4096
    ds_read_b128 a[228:231], v10 offset:5120
    v_mfma_f32_16x16x32_bf16 v[164:167], a[212:215], a[240:243], v[164:167]
    v_fma_f32 v136, v136, s27, v23
    v_fma_f32 v137, v137, s27, v23
    v_mfma_f32_16x16x32_bf16 v[168:171], a[216:219], a[240:243], v[168:171]
    v_exp_f32 v136, v136
    v_mfma_f32_16x16x32_bf16 v[172:175], a[220:223], a[240:243], v[172:175]
    v_exp_f32 v137, v137
    v_mfma_f32_16x16x32_bf16 v[176:179], a[208:211], a[244:247], v[176:179]
    v_cvt_pk_bf16_f32 v52, v136, v137
    v_add_f32 v29, v29, v136
    v_mfma_f32_16x16x32_bf16 v[180:183], a[212:215], a[244:247], v[180:183]
L_iw1:
    s_cbranch_execz L_iw5
    v_add_f32 v29, v29, v137
    v_fma_f32 v138, v138, s27, v23
    v_mfma_f32_16x16x32_bf16 v[184:187], a[216:219], a[244:247], v[184:187]
    v_exp_f32 v138, v138
    v_mfma_f32_16x16x32_bf16 v[188:191], a[220:223], a[244:247], v[188:191]
    s_waitcnt lgkmcnt(2)
    v_add_f32 v29, v29, v138
    v_fma_f32 v139, v139, s27, v23
    v_mfma_f32_16x16x32_bf16 v[192:195], a[208:211], a[248:251], v[192:195]
    s_waitcnt vmcnt(12)
    ds_read_b128 a[192:195], v1 offset:16384
    ds_read_b128 a[196:199], v2 offset:16384
    v_mfma_f32_16x16x32_bf16 v[196:199], a[212:215], a[248:251], v[196:199]
    v_exp_f32 v139, v139
    v_mfma_f32_16x16x32_bf16 v[200:203], a[216:219], a[248:251], v[200:203]
    s_add_u32 m0, s21, 4096
    ds_read_b128 a[200:203], v35 offset:16384
    ds_read_b128 a[204:207], v39 offset:16384
    v_mfma_f32_16x16x32_bf16 v[204:207], a[220:223], a[248:251], v[204:207]
    s_add_u32 s22, s24, s89
    v_cvt_pk_bf16_f32 v53, v138, v139
    v_add_f32 v29, v29, v139
    v_mfma_f32_16x16x32_bf16 v[208:211], a[208:211], a[252:255], v[208:211]
    ds_read_b128 a[232:235], v1 offset:16640
    ds_read_b128 a[236:239], v2 offset:16640
    v_mfma_f32_16x16x32_bf16 v[212:215], a[212:215], a[252:255], v[212:215]
    buffer_load_dwordx4 v15, s[12:15], s22 offen lds
    v_mfma_f32_16x16x32_bf16 v[216:219], a[216:219], a[252:255], v[216:219]
    ds_read_b128 a[240:243], v35 offset:16640
    ds_read_b128 a[244:247], v39 offset:16640
    v_mfma_f32_16x16x32_bf16 v[220:223], a[220:223], a[252:255], v[220:223]
    s_waitcnt lgkmcnt(8)
    v_fma_f32 v140, v140, s27, v23
    v_fma_f32 v141, v141, s27, v23
    v_mfma_f32_16x16x32_bf16 v[224:227], a[208:211], a[224:227], v[224:227]
    buffer_load_dwordx4 v16, s[12:15], s22 offen offset:1024 lds
    v_mfma_f32_16x16x32_bf16 v[228:231], a[212:215], a[224:227], v[228:231]
    v_exp_f32 v140, v140
    v_mfma_f32_16x16x32_bf16 v[232:235], a[216:219], a[224:227], v[232:235]
    v_exp_f32 v141, v141
    v_mfma_f32_16x16x32_bf16 v[236:239], a[220:223], a[224:227], v[236:239]
    v_cvt_pk_bf16_f32 v54, v140, v141
    v_add_f32 v29, v29, v140
    v_mfma_f32_16x16x32_bf16 v[240:243], a[208:211], a[228:231], v[240:243]
    buffer_load_dwordx4 v17, s[12:15], s22 offen offset:2048 lds
    v_mfma_f32_16x16x32_bf16 v[244:247], a[212:215], a[228:231], v[244:247]
    v_add_f32 v29, v29, v141
    v_fma_f32 v142, v142, s27, v23
    v_mfma_f32_16x16x32_bf16 v[248:251], a[216:219], a[228:231], v[248:251]
    v_exp_f32 v142, v142
    v_mfma_f32_16x16x32_bf16 v[252:255], a[220:223], a[228:231], v[252:255]
    s_waitcnt lgkmcnt(0)
    v_add_f32 v29, v29, v142
    v_fma_f32 v143, v143, s27, v23
    v_mfma_f32_16x16x32_bf16 v[64:67], a[192:195], a[0:3], 0
    buffer_load_dwordx4 v18, s[12:15], s22 offen offset:3072 lds
    v_mfma_f32_16x16x32_bf16 v[64:67], a[196:199], a[4:7], v[64:67]
    v_exp_f32 v143, v143
    v_mfma_f32_16x16x32_bf16 v[64:67], a[200:203], a[8:11], v[64:67]
    v_cvt_pk_bf16_f32 v55, v142, v143
    v_add_f32 v29, v29, v143
    v_mfma_f32_16x16x32_bf16 v[64:67], a[204:207], a[12:15], v[64:67]
    v_fma_f32 v144, v144, s27, v24
    v_fma_f32 v145, v145, s27, v24
    v_mfma_f32_16x16x32_bf16 v[64:67], a[232:235], a[16:19], v[64:67]
    s_add_u32 m0, s21, 8192
    v_exp_f32 v144, v144
    v_mfma_f32_16x16x32_bf16 v[64:67], a[236:239], a[20:23], v[64:67]
    s_add_u32 s22, s25, s89
    v_exp_f32 v145, v145
    v_mfma_f32_16x16x32_bf16 v[64:67], a[240:243], a[24:27], v[64:67]
    buffer_load_dwordx4 v15, s[12:15], s22 offen lds
    v_mfma_f32_16x16x32_bf16 v[64:67], a[244:247], a[28:31], v[64:67]
    v_cvt_pk_bf16_f32 v56, v144, v145
    v_add_f32 v30, v30, v144
    v_mfma_f32_16x16x32_bf16 v[72:75], a[192:195], a[32:35], 0
    v_add_f32 v30, v30, v145
    v_fma_f32 v146, v146, s27, v24
    v_mfma_f32_16x16x32_bf16 v[72:75], a[196:199], a[36:39], v[72:75]
    v_exp_f32 v146, v146
    v_mfma_f32_16x16x32_bf16 v[72:75], a[200:203], a[40:43], v[72:75]
    buffer_load_dwordx4 v16, s[12:15], s22 offen offset:1024 lds
    v_mfma_f32_16x16x32_bf16 v[72:75], a[204:207], a[44:47], v[72:75]
    v_add_f32 v30, v30, v146
    v_fma_f32 v147, v147, s27, v24
    v_mfma_f32_16x16x32_bf16 v[72:75], a[232:235], a[48:51], v[72:75]
    s_waitcnt vmcnt(14)
    ds_read_b64_tr_b16 a[208:209], v3 offset:0
    ds_read_b64_tr_b16 a[210:211], v3 offset:2048
    v_mfma_f32_16x16x32_bf16 v[72:75], a[236:239], a[52:55], v[72:75]
    v_exp_f32 v147, v147
    v_mfma_f32_16x16x32_bf16 v[72:75], a[240:243], a[56:59], v[72:75]
    buffer_load_dwordx4 v17, s[12:15], s22 offen offset:2048 lds
    v_mfma_f32_16x16x32_bf16 v[72:75], a[244:247], a[60:63], v[72:75]
    ds_read_b64_tr_b16 a[212:213], v4 offset:0
    ds_read_b64_tr_b16 a[214:215], v4 offset:2048
    v_mfma_f32_16x16x32_bf16 v[80:83], a[192:195], a[64:67], 0
    v_cvt_pk_bf16_f32 v57, v146, v147
    v_add_f32 v30, v30, v147
    v_mfma_f32_16x16x32_bf16 v[80:83], a[196:199], a[68:71], v[80:83]
    v_fma_f32 v148, v148, s27, v24
    v_fma_f32 v149, v149, s27, v24
    v_mfma_f32_16x16x32_bf16 v[80:83], a[200:203], a[72:75], v[80:83]
    ds_read_b64_tr_b16 a[216:217], v5 offset:0
    ds_read_b64_tr_b16 a[218:219], v5 offset:2048
    v_mfma_f32_16x16x32_bf16 v[80:83], a[204:207], a[76:79], v[80:83]
    buffer_load_dwordx4 v18, s[12:15], s22 offen offset:3072 lds
    v_mfma_f32_16x16x32_bf16 v[80:83], a[232:235], a[80:83], v[80:83]
    v_exp_f32 v148, v148
    v_mfma_f32_16x16x32_bf16 v[80:83], a[236:239], a[84:87], v[80:83]
    ds_read_b64_tr_b16 a[220:221], v6 offset:0
    ds_read_b64_tr_b16 a[222:223], v6 offset:2048
    v_mfma_f32_16x16x32_bf16 v[80:83], a[240:243], a[88:91], v[80:83]
    s_add_u32 m0, s21, 16384
    v_exp_f32 v149, v149
    v_mfma_f32_16x16x32_bf16 v[80:83], a[244:247], a[92:95], v[80:83]
    s_add_u32 s22, s96, s91
    v_cvt_pk_bf16_f32 v58, v148, v149
    v_add_f32 v30, v30, v148
    v_mfma_f32_16x16x32_bf16 v[88:91], a[192:195], a[96:99], 0
    buffer_load_dwordx4 v11, s[8:11], s22 offen lds
    v_mfma_f32_16x16x32_bf16 v[88:91], a[196:199], a[100:103], v[88:91]
    v_add_f32 v30, v30, v149
    v_fma_f32 v150, v150, s27, v24
    v_mfma_f32_16x16x32_bf16 v[88:91], a[200:203], a[104:107], v[88:91]
    s_waitcnt vmcnt(9)
    ds_read_b128 a[248:251], v1 offset:24576
    ds_read_b128 a[252:255], v2 offset:24576
    v_mfma_f32_16x16x32_bf16 v[88:91], a[204:207], a[108:111], v[88:91]
    v_exp_f32 v150, v150
    v_mfma_f32_16x16x32_bf16 v[88:91], a[232:235], a[112:115], v[88:91]
    ds_read_b128 a[224:227], v35 offset:24576
    ds_read_b128 a[228:231], v39 offset:24576
    v_mfma_f32_16x16x32_bf16 v[88:91], a[236:239], a[116:119], v[88:91]
    buffer_load_dwordx4 v12, s[8:11], s22 offen offset:1024 lds
    v_mfma_f32_16x16x32_bf16 v[88:91], a[240:243], a[120:123], v[88:91]
    v_add_f32 v30, v30, v150
    v_fma_f32 v151, v151, s27, v24
    v_mfma_f32_16x16x32_bf16 v[88:91], a[244:247], a[124:127], v[88:91]
    v_exp_f32 v151, v151
    v_mfma_f32_16x16x32_bf16 v[96:99], a[192:195], a[128:131], 0
    v_cvt_pk_bf16_f32 v59, v150, v151
    v_add_f32 v30, v30, v151
    v_mfma_f32_16x16x32_bf16 v[96:99], a[196:199], a[132:135], v[96:99]
    v_fma_f32 v152, v152, s27, v25
    v_fma_f32 v153, v153, s27, v25
    v_mfma_f32_16x16x32_bf16 v[96:99], a[200:203], a[136:139], v[96:99]
    buffer_load_dwordx4 v13, s[8:11], s22 offen offset:2048 lds
    v_mfma_f32_16x16x32_bf16 v[96:99], a[204:207], a[140:143], v[96:99]
    v_exp_f32 v152, v152
    v_mfma_f32_16x16x32_bf16 v[96:99], a[232:235], a[144:147], v[96:99]
    v_exp_f32 v153, v153
    v_mfma_f32_16x16x32_bf16 v[96:99], a[236:239], a[148:151], v[96:99]
    v_cvt_pk_bf16_f32 v60, v152, v153
    v_add_f32 v31, v31, v152
    v_mfma_f32_16x16x32_bf16 v[96:99], a[240:243], a[152:155], v[96:99]
    v_add_f32 v31, v31, v153
    v_fma_f32 v154, v154, s27, v25
    v_mfma_f32_16x16x32_bf16 v[96:99], a[244:247], a[156:159], v[96:99]
    buffer_load_dwordx4 v14, s[8:11], s22 offen offset:3072 lds
    v_mfma_f32_16x16x32_bf16 v[104:107], a[192:195], a[160:163], 0
    v_exp_f32 v154, v154
    v_mfma_f32_16x16x32_bf16 v[104:107], a[196:199], a[164:167], v[104:107]
    ds_read_b128 a[192:195], v1 offset:24832
    ds_read_b128 a[196:199], v2 offset:24832
    v_mfma_f32_16x16x32_bf16 v[104:107], a[200:203], a[168:171], v[104:107]
    v_add_f32 v31, v31, v154
    v_fma_f32 v155, v155, s27, v25
    v_mfma_f32_16x16x32_bf16 v[104:107], a[204:207], a[172:175], v[104:107]
    ds_read_b128 a[200:203], v35 offset:24832
    ds_read_b128 a[204:207], v39 offset:24832
    v_mfma_f32_16x16x32_bf16 v[104:107], a[232:235], a[176:179], v[104:107]
    s_add_u32 m0, s21, 0
    s_barrier
    v_mfma_f32_16x16x32_bf16 v[104:107], a[236:239], a[180:183], v[104:107]
    s_add_u32 s22, s23, s90
    ds_write_b128 v7, v[40:43] offset:0
    v_mfma_f32_16x16x32_bf16 v[104:107], a[240:243], a[184:187], v[104:107]
    s_waitcnt lgkmcnt(5)
    buffer_load_dwordx4 v15, s[12:15], s22 offen lds
    v_mfma_f32_16x16x32_bf16 v[104:107], a[244:247], a[188:191], v[104:107]
    v_exp_f32 v155, v155
    v_mfma_f32_16x16x32_bf16 v[68:71], a[248:251], a[0:3], 0
    v_cvt_pk_bf16_f32 v61, v154, v155
    v_add_f32 v31, v31, v155
    v_mfma_f32_16x16x32_bf16 v[68:71], a[252:255], a[4:7], v[68:71]
    ds_write_b128 v7, v[44:47] offset:1024
    v_mfma_f32_16x16x32_bf16 v[68:71], a[224:227], a[8:11], v[68:71]
    v_fma_f32 v156, v156, s27, v25
    v_fma_f32 v157, v157, s27, v25
    v_mfma_f32_16x16x32_bf16 v[68:71], a[228:231], a[12:15], v[68:71]
    s_waitcnt lgkmcnt(2)
    buffer_load_dwordx4 v16, s[12:15], s22 offen offset:1024 lds
    v_mfma_f32_16x16x32_bf16 v[68:71], a[192:195], a[16:19], v[68:71]
    v_exp_f32 v156, v156
    v_mfma_f32_16x16x32_bf16 v[68:71], a[196:199], a[20:23], v[68:71]
    ds_write_b128 v7, v[48:51] offset:2048
    v_mfma_f32_16x16x32_bf16 v[68:71], a[200:203], a[24:27], v[68:71]
    v_exp_f32 v157, v157
    v_mfma_f32_16x16x32_bf16 v[68:71], a[204:207], a[28:31], v[68:71]
    v_cvt_pk_bf16_f32 v62, v156, v157
    v_add_f32 v31, v31, v156
    v_mfma_f32_16x16x32_bf16 v[76:79], a[248:251], a[32:35], 0
    buffer_load_dwordx4 v17, s[12:15], s22 offen offset:2048 lds
    v_mfma_f32_16x16x32_bf16 v[76:79], a[252:255], a[36:39], v[76:79]
    ds_write_b128 v7, v[52:55] offset:3072
    v_mfma_f32_16x16x32_bf16 v[76:79], a[224:227], a[40:43], v[76:79]
    v_add_f32 v31, v31, v157
    v_fma_f32 v158, v158, s27, v25
    v_mfma_f32_16x16x32_bf16 v[76:79], a[228:231], a[44:47], v[76:79]
    v_exp_f32 v158, v158
    v_mfma_f32_16x16x32_bf16 v[76:79], a[192:195], a[48:51], v[76:79]
    v_add_f32 v31, v31, v158
    v_fma_f32 v159, v159, s27, v25
    v_mfma_f32_16x16x32_bf16 v[76:79], a[196:199], a[52:55], v[76:79]
    buffer_load_dwordx4 v18, s[12:15], s22 offen offset:3072 lds
    v_mfma_f32_16x16x32_bf16 v[76:79], a[200:203], a[56:59], v[76:79]
    ds_write_b128 v7, v[56:59] offset:4096
    v_mfma_f32_16x16x32_bf16 v[76:79], a[204:207], a[60:63], v[76:79]
    v_exp_f32 v159, v159
    v_mfma_f32_16x16x32_bf16 v[84:87], a[248:251], a[64:67], 0
    v_cvt_pk_bf16_f32 v63, v158, v159
    v_add_f32 v31, v31, v159
    v_mfma_f32_16x16x32_bf16 v[84:87], a[252:255], a[68:71], v[84:87]
    v_fma_f32 v64, v64, s27, v20
    v_fma_f32 v65, v65, s27, v20
    v_mfma_f32_16x16x32_bf16 v[84:87], a[224:227], a[72:75], v[84:87]
    ds_write_b128 v7, v[60:63] offset:5120
    v_mfma_f32_16x16x32_bf16 v[84:87], a[228:231], a[76:79], v[84:87]
    v_exp_f32 v64, v64
    v_mfma_f32_16x16x32_bf16 v[84:87], a[192:195], a[80:83], v[84:87]
    s_add_u32 m0, s21, 12288
    v_exp_f32 v65, v65
    v_mfma_f32_16x16x32_bf16 v[84:87], a[196:199], a[84:87], v[84:87]
    s_add_u32 s22, s26, s89
    v_add_f32 v26, v26, v64
    v_fma_f32 v66, v66, s27, v20
    v_mfma_f32_16x16x32_bf16 v[84:87], a[200:203], a[88:91], v[84:87]
    buffer_load_dwordx4 v15, s[12:15], s22 offen lds
    v_mfma_f32_16x16x32_bf16 v[84:87], a[204:207], a[92:95], v[84:87]
    v_exp_f32 v66, v66
    v_mfma_f32_16x16x32_bf16 v[92:95], a[248:251], a[96:99], 0
    v_add_f32 v26, v26, v65
    v_fma_f32 v67, v67, s27, v20
    v_mfma_f32_16x16x32_bf16 v[92:95], a[252:255], a[100:103], v[92:95]
    v_exp_f32 v67, v67
    v_mfma_f32_16x16x32_bf16 v[92:95], a[224:227], a[104:107], v[92:95]
    buffer_load_dwordx4 v16, s[12:15], s22 offen offset:1024 lds
    v_mfma_f32_16x16x32_bf16 v[92:95], a[228:231], a[108:111], v[92:95]
    v_add_f32 v26, v26, v66
    v_fma_f32 v68, v68, s27, v20
    v_mfma_f32_16x16x32_bf16 v[92:95], a[192:195], a[112:115], v[92:95]
    v_exp_f32 v68, v68
    v_mfma_f32_16x16x32_bf16 v[92:95], a[196:199], a[116:119], v[92:95]
    v_add_f32 v26, v26, v67
    v_fma_f32 v69, v69, s27, v20
    v_mfma_f32_16x16x32_bf16 v[92:95], a[200:203], a[120:123], v[92:95]
    buffer_load_dwordx4 v17, s[12:15], s22 offen offset:2048 lds
    v_mfma_f32_16x16x32_bf16 v[92:95], a[204:207], a[124:127], v[92:95]
    v_exp_f32 v69, v69
    v_mfma_f32_16x16x32_bf16 v[100:103], a[248:251], a[128:131], 0
    v_add_f32 v26, v26, v68
    v_fma_f32 v70, v70, s27, v20
    v_mfma_f32_16x16x32_bf16 v[100:103], a[252:255], a[132:135], v[100:103]
    v_exp_f32 v70, v70
    v_mfma_f32_16x16x32_bf16 v[100:103], a[224:227], a[136:139], v[100:103]
    buffer_load_dwordx4 v18, s[12:15], s22 offen offset:3072 lds
    v_mfma_f32_16x16x32_bf16 v[100:103], a[228:231], a[140:143], v[100:103]
    v_add_f32 v26, v26, v69
    v_fma_f32 v71, v71, s27, v20
    v_mfma_f32_16x16x32_bf16 v[100:103], a[192:195], a[144:147], v[100:103]
    v_exp_f32 v71, v71
    v_mfma_f32_16x16x32_bf16 v[100:103], a[196:199], a[148:151], v[100:103]
    v_add_f32 v26, v26, v70
    v_fma_f32 v72, v72, s27, v21
    v_mfma_f32_16x16x32_bf16 v[100:103], a[200:203], a[152:155], v[100:103]
    v_exp_f32 v72, v72
    v_mfma_f32_16x16x32_bf16 v[100:103], a[204:207], a[156:159], v[100:103]
    v_add_f32 v26, v26, v71
    v_add_f32 v27, v27, v72
    v_mfma_f32_16x16x32_bf16 v[108:111], a[248:251], a[160:163], 0
    v_fma_f32 v73, v73, s27, v21
    v_fma_f32 v74, v74, s27, v21
    v_mfma_f32_16x16x32_bf16 v[108:111], a[252:255], a[164:167], v[108:111]
    v_exp_f32 v73, v73
    v_mfma_f32_16x16x32_bf16 v[108:111], a[224:227], a[168:171], v[108:111]
    v_exp_f32 v74, v74
    v_mfma_f32_16x16x32_bf16 v[108:111], a[228:231], a[172:175], v[108:111]
    v_add_f32 v27, v27, v73
    v_fma_f32 v75, v75, s27, v21
    v_mfma_f32_16x16x32_bf16 v[108:111], a[192:195], a[176:179], v[108:111]
    v_exp_f32 v75, v75
    v_mfma_f32_16x16x32_bf16 v[108:111], a[196:199], a[180:183], v[108:111]
    v_add_f32 v27, v27, v74
    v_fma_f32 v76, v76, s27, v21
    v_mfma_f32_16x16x32_bf16 v[108:111], a[200:203], a[184:187], v[108:111]
    v_exp_f32 v76, v76
    v_mfma_f32_16x16x32_bf16 v[108:111], a[204:207], a[188:191], v[108:111]
    s_add_u32 m0, s21, 20480
    v_add_f32 v27, v27, v75
    v_fma_f32 v77, v77, s27, v21
    v_mfma_f32_16x16x32_bf16 v[160:163], a[208:211], v[40:43], v[160:163]
    s_waitcnt vmcnt(16)
    ds_read_b64_tr_b16 a[192:193], v3 offset:4096
    ds_read_b64_tr_b16 a[194:195], v3 offset:6144
    v_mfma_f32_16x16x32_bf16 v[164:167], a[212:215], v[40:43], v[164:167]
    s_add_u32 s22, s97, s91
    v_exp_f32 v77, v77
    v_mfma_f32_16x16x32_bf16 v[168:171], a[216:219], v[40:43], v[168:171]
    buffer_load_dwordx4 v11, s[8:11], s22 offen lds
    v_mfma_f32_16x16x32_bf16 v[172:175], a[220:223], v[40:43], v[172:175]
    ds_read_b64_tr_b16 a[196:197], v4 offset:4096
    ds_read_b64_tr_b16 a[198:199], v4 offset:6144
    v_mfma_f32_16x16x32_bf16 v[176:179], a[208:211], v[44:47], v[176:179]
    v_cvt_pk_bf16_f32 v40, v64, v65
    v_cvt_pk_bf16_f32 v41, v66, v67
    v_mfma_f32_16x16x32_bf16 v[180:183], a[212:215], v[44:47], v[180:183]
    v_cvt_pk_bf16_f32 v42, v68, v69
    v_cvt_pk_bf16_f32 v43, v70, v71
    v_mfma_f32_16x16x32_bf16 v[184:187], a[216:219], v[44:47], v[184:187]
    ds_read_b64_tr_b16 a[200:201], v5 offset:4096
    ds_read_b64_tr_b16 a[202:203], v5 offset:6144
    v_mfma_f32_16x16x32_bf16 v[188:191], a[220:223], v[44:47], v[188:191]
    buffer_load_dwordx4 v12, s[8:11], s22 offen offset:1024 lds
    v_mfma_f32_16x16x32_bf16 v[192:195], a[208:211], v[48:51], v[192:195]
    v_cvt_pk_bf16_f32 v44, v72, v73
    v_cvt_pk_bf16_f32 v45, v74, v75
    v_mfma_f32_16x16x32_bf16 v[196:199], a[212:215], v[48:51], v[196:199]
    ds_read_b64_tr_b16 a[204:205], v6 offset:4096
    ds_read_b64_tr_b16 a[206:207], v6 offset:6144
    v_mfma_f32_16x16x32_bf16 v[200:203], a[216:219], v[48:51], v[200:203]
    buffer_load_dwordx4 v13, s[8:11], s22 offen offset:2048 lds
    v_mfma_f32_16x16x32_bf16 v[204:207], a[220:223], v[48:51], v[204:207]
    v_cvt_pk_bf16_f32 v46, v76, v77
    v_add_f32 v27, v27, v76
    v_mfma_f32_16x16x32_bf16 v[208:211], a[208:211], v[52:55], v[208:211]
    v_add_f32 v27, v27, v77
    v_fma_f32 v78, v78, s27, v21
    v_mfma_f32_16x16x32_bf16 v[212:215], a[212:215], v[52:55], v[212:215]
    v_exp_f32 v78, v78
    v_mfma_f32_16x16x32_bf16 v[216:219], a[216:219], v[52:55], v[216:219]
    buffer_load_dwordx4 v14, s[8:11], s22 offen offset:3072 lds
    v_mfma_f32_16x16x32_bf16 v[220:223], a[220:223], v[52:55], v[220:223]
    s_waitcnt lgkmcnt(2)
    s_barrier
    v_mfma_f32_16x16x32_bf16 v[224:227], a[208:211], v[56:59], v[224:227]
    ds_read_b128 a[224:227], v8 offset:0
    ds_read_b128 a[228:231], v8 offset:1024
    v_mfma_f32_16x16x32_bf16 v[228:231], a[212:215], v[56:59], v[228:231]
    v_add_f32 v27, v27, v78
    v_fma_f32 v79, v79, s27, v21
    v_mfma_f32_16x16x32_bf16 v[232:235], a[216:219], v[56:59], v[232:235]
    s_add_u32 m0, s21, 24576
    v_exp_f32 v79, v79
    v_mfma_f32_16x16x32_bf16 v[236:239], a[220:223], v[56:59], v[236:239]
    s_add_u32 s22, s98, s91
    ds_read_b128 a[232:235], v8 offset:2048
    ds_read_b128 a[236:239], v8 offset:3072
    v_mfma_f32_16x16x32_bf16 v[240:243], a[208:211], v[60:63], v[240:243]
    buffer_load_dwordx4 v11, s[8:11], s22 offen lds
    v_mfma_f32_16x16x32_bf16 v[244:247], a[212:215], v[60:63], v[244:247]
    v_cvt_pk_bf16_f32 v47, v78, v79
    v_add_f32 v27, v27, v79
    v_mfma_f32_16x16x32_bf16 v[248:251], a[216:219], v[60:63], v[248:251]
    v_fma_f32 v80, v80, s27, v22
    v_fma_f32 v81, v81, s27, v22
    v_mfma_f32_16x16x32_bf16 v[252:255], a[220:223], v[60:63], v[252:255]
    s_waitcnt lgkmcnt(3)
    v_exp_f32 v80, v80
    v_mfma_f32_16x16x32_bf16 v[160:163], a[192:195], a[224:227], v[160:163]
    ds_read_b128 a[240:243], v8 offset:4096
    ds_read_b128 a[244:247], v8 offset:5120
    v_mfma_f32_16x16x32_bf16 v[164:167], a[196:199], a[224:227], v[164:167]
    buffer_load_dwordx4 v12, s[8:11], s22 offen offset:1024 lds
    v_mfma_f32_16x16x32_bf16 v[168:171], a[200:203], a[224:227], v[168:171]
    s_waitcnt vmcnt(18)
    ds_read_b64_tr_b16 a[208:209], v3 offset:8192
    ds_read_b64_tr_b16 a[210:211], v3 offset:10240
    v_mfma_f32_16x16x32_bf16 v[172:175], a[204:207], a[224:227], v[172:175]
    s_waitcnt lgkmcnt(4)
    v_exp_f32 v81, v81
    v_mfma_f32_16x16x32_bf16 v[176:179], a[192:195], a[228:231], v[176:179]
    buffer_load_dwordx4 v13, s[8:11], s22 offen offset:2048 lds
    v_mfma_f32_16x16x32_bf16 v[180:183], a[196:199], a[228:231], v[180:183]
    v_cvt_pk_bf16_f32 v48, v80, v81
    v_add_f32 v28, v28, v80
    v_mfma_f32_16x16x32_bf16 v[184:187], a[200:203], a[228:231], v[184:187]
    ds_read_b64_tr_b16 a[212:213], v4 offset:8192
    ds_read_b64_tr_b16 a[214:215], v4 offset:10240
    v_mfma_f32_16x16x32_bf16 v[188:191], a[204:207], a[228:231], v[188:191]
    v_add_f32 v28, v28, v81
    v_fma_f32 v82, v82, s27, v22
    v_mfma_f32_16x16x32_bf16 v[192:195], a[192:195], a[232:235], v[192:195]
    ds_read_b128 a[248:251], v9 offset:0
    ds_read_b128 a[252:255], v9 offset:1024
    v_mfma_f32_16x16x32_bf16 v[196:199], a[196:199], a[232:235], v[196:199]
    buffer_load_dwordx4 v14, s[8:11], s22 offen offset:3072 lds
    v_mfma_f32_16x16x32_bf16 v[200:203], a[200:203], a[232:235], v[200:203]
    ds_read_b64_tr_b16 a[216:217], v5 offset:8192
    ds_read_b64_tr_b16 a[218:219], v5 offset:10240
    v_mfma_f32_16x16x32_bf16 v[204:207], a[204:207], a[232:235], v[204:207]
    v_exp_f32 v82, v82
    v_mfma_f32_16x16x32_bf16 v[208:211], a[192:195], a[236:239], v[208:211]
    s_add_u32 m0, s21, 28672
    v_add_f32 v28, v28, v82
    v_fma_f32 v83, v83, s27, v22
    v_mfma_f32_16x16x32_bf16 v[212:215], a[196:199], a[236:239], v[212:215]
    s_add_u32 s22, s99, s91
    v_exp_f32 v83, v83
    v_mfma_f32_16x16x32_bf16 v[216:219], a[200:203], a[236:239], v[216:219]
    ds_read_b64_tr_b16 a[220:221], v6 offset:8192
    ds_read_b64_tr_b16 a[222:223], v6 offset:10240
    v_mfma_f32_16x16x32_bf16 v[220:223], a[204:207], a[236:239], v[220:223]
    s_waitcnt lgkmcnt(6)
    buffer_load_dwordx4 v11, s[8:11], s22 offen lds
    v_mfma_f32_16x16x32_bf16 v[224:227], a[192:195], a[240:243], v[224:227]
    ds_read_b128 a[224:227], v9 offset:2048
    ds_read_b128 a[228:231], v9 offset:3072
    v_mfma_f32_16x16x32_bf16 v[228:231], a[196:199], a[240:243], v[228:231]
    v_cvt_pk_bf16_f32 v49, v82, v83
    v_add_f32 v28, v28, v83
    v_mfma_f32_16x16x32_bf16 v[232:235], a[200:203], a[240:243], v[232:235]
    v_fma_f32 v84, v84, s27, v22
    v_fma_f32 v85, v85, s27, v22
    v_mfma_f32_16x16x32_bf16 v[236:239], a[204:207], a[240:243], v[236:239]
    buffer_load_dwordx4 v12, s[8:11], s22 offen offset:1024 lds
    v_mfma_f32_16x16x32_bf16 v[240:243], a[192:195], a[244:247], v[240:243]
    v_exp_f32 v84, v84
    v_mfma_f32_16x16x32_bf16 v[244:247], a[196:199], a[244:247], v[244:247]
    v_exp_f32 v85, v85
    v_mfma_f32_16x16x32_bf16 v[248:251], a[200:203], a[244:247], v[248:251]
    v_cvt_pk_bf16_f32 v50, v84, v85
    v_add_f32 v28, v28, v84
    v_mfma_f32_16x16x32_bf16 v[252:255], a[204:207], a[244:247], v[252:255]
    s_waitcnt lgkmcnt(2)
    v_add_f32 v28, v28, v85
    v_fma_f32 v86, v86, s27, v22
    v_mfma_f32_16x16x32_bf16 v[160:163], a[208:211], a[248:251], v[160:163]
    ds_read_b128 a[232:235], v9 offset:4096
    ds_read_b128 a[236:239], v9 offset:5120
    v_mfma_f32_16x16x32_bf16 v[164:167], a[212:215], a[248:251], v[164:167]
    buffer_load_dwordx4 v13, s[8:11], s22 offen offset:2048 lds
    v_mfma_f32_16x16x32_bf16 v[168:171], a[216:219], a[248:251], v[168:171]
    s_waitcnt vmcnt(11)
    ds_read_b64_tr_b16 a[192:193], v3 offset:12288
    ds_read_b64_tr_b16 a[194:195], v3 offset:14336
    v_mfma_f32_16x16x32_bf16 v[172:175], a[220:223], a[248:251], v[172:175]
    v_exp_f32 v86, v86
    v_mfma_f32_16x16x32_bf16 v[176:179], a[208:211], a[252:255], v[176:179]
    v_add_f32 v28, v28, v86
    v_fma_f32 v87, v87, s27, v22
    v_mfma_f32_16x16x32_bf16 v[180:183], a[212:215], a[252:255], v[180:183]
    buffer_load_dwordx4 v14, s[8:11], s22 offen offset:3072 lds
    v_mfma_f32_16x16x32_bf16 v[184:187], a[216:219], a[252:255], v[184:187]
    ds_read_b64_tr_b16 a[196:197], v4 offset:12288
    ds_read_b64_tr_b16 a[198:199], v4 offset:14336
    v_mfma_f32_16x16x32_bf16 v[188:191], a[220:223], a[252:255], v[188:191]
    s_waitcnt lgkmcnt(6)
    v_exp_f32 v87, v87
    v_mfma_f32_16x16x32_bf16 v[192:195], a[208:211], a[224:227], v[192:195]
    s_add_u32 m0, s21, 4096
    ds_read_b128 a[240:243], v10 offset:0
    ds_read_b128 a[244:247], v10 offset:1024
    v_mfma_f32_16x16x32_bf16 v[196:199], a[212:215], a[224:227], v[196:199]
    s_add_u32 s22, s24, s90
    v_cvt_pk_bf16_f32 v51, v86, v87
    v_add_f32 v28, v28, v87
    v_mfma_f32_16x16x32_bf16 v[200:203], a[216:219], a[224:227], v[200:203]
    ds_read_b64_tr_b16 a[200:201], v5 offset:12288
    ds_read_b64_tr_b16 a[202:203], v5 offset:14336
    v_mfma_f32_16x16x32_bf16 v[204:207], a[220:223], a[224:227], v[204:207]
    buffer_load_dwordx4 v15, s[12:15], s22 offen lds
    v_mfma_f32_16x16x32_bf16 v[208:211], a[208:211], a[228:231], v[208:211]
    v_fma_f32 v88, v88, s27, v23
    v_fma_f32 v89, v89, s27, v23
    v_mfma_f32_16x16x32_bf16 v[212:215], a[212:215], a[228:231], v[212:215]
    v_exp_f32 v88, v88
    v_mfma_f32_16x16x32_bf16 v[216:219], a[216:219], a[228:231], v[216:219]
    ds_read_b64_tr_b16 a[204:205], v6 offset:12288
    ds_read_b64_tr_b16 a[206:207], v6 offset:14336
    v_mfma_f32_16x16x32_bf16 v[220:223], a[220:223], a[228:231], v[220:223]
    s_waitcnt lgkmcnt(6)
    buffer_load_dwordx4 v16, s[12:15], s22 offen offset:1024 lds
    v_mfma_f32_16x16x32_bf16 v[224:227], a[208:211], a[232:235], v[224:227]
    ds_read_b128 a[248:251], v10 offset:2048
    ds_read_b128 a[252:255], v10 offset:3072
    v_mfma_f32_16x16x32_bf16 v[228:231], a[212:215], a[232:235], v[228:231]
    v_exp_f32 v89, v89
    v_mfma_f32_16x16x32_bf16 v[232:235], a[216:219], a[232:235], v[232:235]
    v_cvt_pk_bf16_f32 v52, v88, v89
    v_add_f32 v29, v29, v88
    v_mfma_f32_16x16x32_bf16 v[236:239], a[220:223], a[232:235], v[236:239]
    v_add_f32 v29, v29, v89
    v_fma_f32 v90, v90, s27, v23
    v_mfma_f32_16x16x32_bf16 v[240:243], a[208:211], a[236:239], v[240:243]
    buffer_load_dwordx4 v17, s[12:15], s22 offen offset:2048 lds
    v_mfma_f32_16x16x32_bf16 v[244:247], a[212:215], a[236:239], v[244:247]
    v_exp_f32 v90, v90
    v_mfma_f32_16x16x32_bf16 v[248:251], a[216:219], a[236:239], v[248:251]
    v_add_f32 v29, v29, v90
    v_fma_f32 v91, v91, s27, v23
    v_mfma_f32_16x16x32_bf16 v[252:255], a[220:223], a[236:239], v[252:255]
    s_waitcnt lgkmcnt(2)
    v_exp_f32 v91, v91
    v_mfma_f32_16x16x32_bf16 v[160:163], a[192:195], a[240:243], v[160:163]
    ds_read_b128 a[224:227], v10 offset:4096
    ds_read_b128 a[228:231], v10 offset:5120
    v_mfma_f32_16x16x32_bf16 v[164:167], a[196:199], a[240:243], v[164:167]
    buffer_load_dwordx4 v18, s[12:15], s22 offen offset:3072 lds
    v_mfma_f32_16x16x32_bf16 v[168:171], a[200:203], a[240:243], v[168:171]
    v_cvt_pk_bf16_f32 v53, v90, v91
    v_add_f32 v29, v29, v91
    v_mfma_f32_16x16x32_bf16 v[172:175], a[204:207], a[240:243], v[172:175]
    v_fma_f32 v92, v92, s27, v23
    v_fma_f32 v93, v93, s27, v23
    v_mfma_f32_16x16x32_bf16 v[176:179], a[192:195], a[244:247], v[176:179]
    s_add_u32 m0, s21, 8192
    v_exp_f32 v92, v92
    v_mfma_f32_16x16x32_bf16 v[180:183], a[196:199], a[244:247], v[180:183]
    s_add_u32 s22, s25, s90
    v_exp_f32 v93, v93
    v_mfma_f32_16x16x32_bf16 v[184:187], a[200:203], a[244:247], v[184:187]
    buffer_load_dwordx4 v15, s[12:15], s22 offen lds
    v_mfma_f32_16x16x32_bf16 v[188:191], a[204:207], a[244:247], v[188:191]
    s_waitcnt lgkmcnt(2)
    v_cvt_pk_bf16_f32 v54, v92, v93
    v_add_f32 v29, v29, v92
    v_mfma_f32_16x16x32_bf16 v[192:195], a[192:195], a[248:251], v[192:195]
    s_waitcnt vmcnt(13)
    ds_read_b128 a[208:211], v1 offset:16384
    ds_read_b128 a[212:215], v2 offset:16384
    v_mfma_f32_16x16x32_bf16 v[196:199], a[196:199], a[248:251], v[196:199]
    v_add_f32 v29, v29, v93
    v_fma_f32 v94, v94, s27, v23
    v_mfma_f32_16x16x32_bf16 v[200:203], a[200:203], a[248:251], v[200:203]
    ds_read_b128 a[216:219], v35 offset:16384
    ds_read_b128 a[220:223], v39 offset:16384
    v_mfma_f32_16x16x32_bf16 v[204:207], a[204:207], a[248:251], v[204:207]
    buffer_load_dwordx4 v16, s[12:15], s22 offen offset:1024 lds
    v_mfma_f32_16x16x32_bf16 v[208:211], a[192:195], a[252:255], v[208:211]
    ds_read_b128 a[232:235], v1 offset:16640
    ds_read_b128 a[236:239], v2 offset:16640
    v_mfma_f32_16x16x32_bf16 v[212:215], a[196:199], a[252:255], v[212:215]
    v_exp_f32 v94, v94
    v_mfma_f32_16x16x32_bf16 v[216:219], a[200:203], a[252:255], v[216:219]
    ds_read_b128 a[240:243], v35 offset:16640
    ds_read_b128 a[244:247], v39 offset:16640
    v_mfma_f32_16x16x32_bf16 v[220:223], a[204:207], a[252:255], v[220:223]
    s_waitcnt lgkmcnt(8)
    buffer_load_dwordx4 v17, s[12:15], s22 offen offset:2048 lds
    v_mfma_f32_16x16x32_bf16 v[224:227], a[192:195], a[224:227], v[224:227]
    v_add_f32 v29, v29, v94
    v_fma_f32 v95, v95, s27, v23
    v_mfma_f32_16x16x32_bf16 v[228:231], a[196:199], a[224:227], v[228:231]
    v_exp_f32 v95, v95
    v_mfma_f32_16x16x32_bf16 v[232:235], a[200:203], a[224:227], v[232:235]
    buffer_load_dwordx4 v18, s[12:15], s22 offen offset:3072 lds
    v_mfma_f32_16x16x32_bf16 v[236:239], a[204:207], a[224:227], v[236:239]
    v_cvt_pk_bf16_f32 v55, v94, v95
    v_add_f32 v29, v29, v95
    v_mfma_f32_16x16x32_bf16 v[240:243], a[192:195], a[228:231], v[240:243]
    s_add_u32 m0, s21, 12288
    v_fma_f32 v96, v96, s27, v24
    v_fma_f32 v97, v97, s27, v24
    v_mfma_f32_16x16x32_bf16 v[244:247], a[196:199], a[228:231], v[244:247]
    s_add_u32 s22, s26, s90
    v_exp_f32 v96, v96
    v_mfma_f32_16x16x32_bf16 v[248:251], a[200:203], a[228:231], v[248:251]
    buffer_load_dwordx4 v15, s[12:15], s22 offen lds
    v_mfma_f32_16x16x32_bf16 v[252:255], a[204:207], a[228:231], v[252:255]
    s_waitcnt lgkmcnt(0)
    v_exp_f32 v97, v97
    v_mfma_f32_16x16x32_bf16 v[112:115], a[208:211], a[0:3], 0
    v_cvt_pk_bf16_f32 v56, v96, v97
    v_add_f32 v30, v30, v96
    v_mfma_f32_16x16x32_bf16 v[112:115], a[212:215], a[4:7], v[112:115]
    ds_read_b64_tr_b16 a[192:193], v3 offset:0
    ds_read_b64_tr_b16 a[194:195], v3 offset:2048
    v_mfma_f32_16x16x32_bf16 v[112:115], a[216:219], a[8:11], v[112:115]
    buffer_load_dwordx4 v16, s[12:15], s22 offen offset:1024 lds
    v_mfma_f32_16x16x32_bf16 v[112:115], a[220:223], a[12:15], v[112:115]
    ds_read_b64_tr_b16 a[196:197], v4 offset:0
    ds_read_b64_tr_b16 a[198:199], v4 offset:2048
    v_mfma_f32_16x16x32_bf16 v[112:115], a[232:235], a[16:19], v[112:115]
    v_add_f32 v30, v30, v97
    v_fma_f32 v98, v98, s27, v24
    v_mfma_f32_16x16x32_bf16 v[112:115], a[236:239], a[20:23], v[112:115]
L_iw2:
    s_cbranch_execz L_iw6
    ds_read_b64_tr_b16 a[200:201], v5 offset:0
    ds_read_b64_tr_b16 a[202:203], v5 offset:2048
    v_mfma_f32_16x16x32_bf16 v[112:115], a[240:243], a[24:27], v[112:115]
    buffer_load_dwordx4 v17, s[12:15], s22 offen offset:2048 lds
    v_mfma_f32_16x16x32_bf16 v[112:115], a[244:247], a[28:31], v[112:115]
    ds_read_b64_tr_b16 a[204:205], v6 offset:0
    ds_read_b64_tr_b16 a[206:207], v6 offset:2048
    v_mfma_f32_16x16x32_bf16 v[120:123], a[208:211], a[32:35], 0
    v_exp_f32 v98, v98
    v_mfma_f32_16x16x32_bf16 v[120:123], a[212:215], a[36:39], v[120:123]
    v_add_f32 v30, v30, v98
    v_fma_f32 v99, v99, s27, v24
    v_mfma_f32_16x16x32_bf16 v[120:123], a[216:219], a[40:43], v[120:123]
    buffer_load_dwordx4 v18, s[12:15], s22 offen offset:3072 lds
    v_mfma_f32_16x16x32_bf16 v[120:123], a[220:223], a[44:47], v[120:123]
    v_exp_f32 v99, v99
    v_mfma_f32_16x16x32_bf16 v[120:123], a[232:235], a[48:51], v[120:123]
    v_cvt_pk_bf16_f32 v57, v98, v99
    v_add_f32 v30, v30, v99
    v_mfma_f32_16x16x32_bf16 v[120:123], a[236:239], a[52:55], v[120:123]
    v_fma_f32 v100, v100, s27, v24
    v_fma_f32 v101, v101, s27, v24
    v_mfma_f32_16x16x32_bf16 v[120:123], a[240:243], a[56:59], v[120:123]
    s_add_u32 m0, s21, 16384
    v_exp_f32 v100, v100
    v_mfma_f32_16x16x32_bf16 v[120:123], a[244:247], a[60:63], v[120:123]
    s_add_u32 s22, s96, s92
    v_exp_f32 v101, v101
    v_mfma_f32_16x16x32_bf16 v[128:131], a[208:211], a[64:67], 0
    buffer_load_dwordx4 v11, s[8:11], s22 offen lds
    v_mfma_f32_16x16x32_bf16 v[128:131], a[212:215], a[68:71], v[128:131]
    v_cvt_pk_bf16_f32 v58, v100, v101
    v_add_f32 v30, v30, v100
    v_mfma_f32_16x16x32_bf16 v[128:131], a[216:219], a[72:75], v[128:131]
    v_add_f32 v30, v30, v101
    v_fma_f32 v102, v102, s27, v24
    v_mfma_f32_16x16x32_bf16 v[128:131], a[220:223], a[76:79], v[128:131]
    v_exp_f32 v102, v102
    v_mfma_f32_16x16x32_bf16 v[128:131], a[232:235], a[80:83], v[128:131]
    v_add_f32 v30, v30, v102
    v_fma_f32 v103, v103, s27, v24
    v_mfma_f32_16x16x32_bf16 v[128:131], a[236:239], a[84:87], v[128:131]
    v_exp_f32 v103, v103
    v_mfma_f32_16x16x32_bf16 v[128:131], a[240:243], a[88:91], v[128:131]
    buffer_load_dwordx4 v12, s[8:11], s22 offen offset:1024 lds
    v_mfma_f32_16x16x32_bf16 v[128:131], a[244:247], a[92:95], v[128:131]
    v_cvt_pk_bf16_f32 v59, v102, v103
    v_add_f32 v30, v30, v103
    v_mfma_f32_16x16x32_bf16 v[136:139], a[208:211], a[96:99], 0
    v_fma_f32 v104, v104, s27, v25
    v_fma_f32 v105, v105, s27, v25
    v_mfma_f32_16x16x32_bf16 v[136:139], a[212:215], a[100:103], v[136:139]
    v_exp_f32 v104, v104
    v_mfma_f32_16x16x32_bf16 v[136:139], a[216:219], a[104:107], v[136:139]
    s_waitcnt vmcnt(14)
    ds_read_b128 a[248:251], v1 offset:24576
    ds_read_b128 a[252:255], v2 offset:24576
    v_mfma_f32_16x16x32_bf16 v[136:139], a[220:223], a[108:111], v[136:139]
    v_exp_f32 v105, v105
    v_mfma_f32_16x16x32_bf16 v[136:139], a[232:235], a[112:115], v[136:139]
    ds_read_b128 a[224:227], v35 offset:24576
    ds_read_b128 a[228:231], v39 offset:24576
    v_mfma_f32_16x16x32_bf16 v[136:139], a[236:239], a[116:119], v[136:139]
    buffer_load_dwordx4 v13, s[8:11], s22 offen offset:2048 lds
    v_mfma_f32_16x16x32_bf16 v[136:139], a[240:243], a[120:123], v[136:139]
    v_cvt_pk_bf16_f32 v60, v104, v105
    v_add_f32 v31, v31, v104
    v_mfma_f32_16x16x32_bf16 v[136:139], a[244:247], a[124:127], v[136:139]
    v_add_f32 v31, v31, v105
    v_fma_f32 v106, v106, s27, v25
    v_mfma_f32_16x16x32_bf16 v[144:147], a[208:211], a[128:131], 0
    v_exp_f32 v106, v106
    v_mfma_f32_16x16x32_bf16 v[144:147], a[212:215], a[132:135], v[144:147]
    v_add_f32 v31, v31, v106
    v_fma_f32 v107, v107, s27, v25
    v_mfma_f32_16x16x32_bf16 v[144:147], a[216:219], a[136:139], v[144:147]
    buffer_load_dwordx4 v14, s[8:11], s22 offen offset:3072 lds
    v_mfma_f32_16x16x32_bf16 v[144:147], a[220:223], a[140:143], v[144:147]
    v_exp_f32 v107, v107
    v_mfma_f32_16x16x32_bf16 v[144:147], a[232:235], a[144:147], v[144:147]
    v_cvt_pk_bf16_f32 v61, v106, v107
    v_add_f32 v31, v31, v107
    v_mfma_f32_16x16x32_bf16 v[144:147], a[236:239], a[148:151], v[144:147]
    v_fma_f32 v108, v108, s27, v25
    v_fma_f32 v109, v109, s27, v25
    v_mfma_f32_16x16x32_bf16 v[144:147], a[240:243], a[152:155], v[144:147]
    v_exp_f32 v108, v108
    v_mfma_f32_16x16x32_bf16 v[144:147], a[244:247], a[156:159], v[144:147]
    v_exp_f32 v109, v109
    v_mfma_f32_16x16x32_bf16 v[152:155], a[208:211], a[160:163], 0
    s_add_u32 m0, s21, 0
    v_cvt_pk_bf16_f32 v62, v108, v109
    v_add_f32 v31, v31, v108
    v_mfma_f32_16x16x32_bf16 v[152:155], a[212:215], a[164:167], v[152:155]
    s_add_u32 s22, s23, s91
    ds_read_b128 a[208:211], v1 offset:24832
    ds_read_b128 a[212:215], v2 offset:24832
    v_mfma_f32_16x16x32_bf16 v[152:155], a[216:219], a[168:171], v[152:155]
    s_waitcnt lgkmcnt(2)
    buffer_load_dwordx4 v15, s[12:15], s22 offen lds
    v_mfma_f32_16x16x32_bf16 v[152:155], a[220:223], a[172:175], v[152:155]
    ds_read_b128 a[216:219], v35 offset:24832
    ds_read_b128 a[220:223], v39 offset:24832
    v_mfma_f32_16x16x32_bf16 v[152:155], a[232:235], a[176:179], v[152:155]
    s_barrier
    v_mfma_f32_16x16x32_bf16 v[152:155], a[236:239], a[180:183], v[152:155]
    ds_write_b128 v7, v[40:43] offset:0
    v_mfma_f32_16x16x32_bf16 v[152:155], a[240:243], a[184:187], v[152:155]
    v_add_f32 v31, v31, v109
    v_fma_f32 v110, v110, s27, v25
    v_mfma_f32_16x16x32_bf16 v[152:155], a[244:247], a[188:191], v[152:155]
    v_exp_f32 v110, v110
    v_mfma_f32_16x16x32_bf16 v[116:119], a[248:251], a[0:3], 0
    buffer_load_dwordx4 v16, s[12:15], s22 offen offset:1024 lds
    v_mfma_f32_16x16x32_bf16 v[116:119], a[252:255], a[4:7], v[116:119]
    ds_write_b128 v7, v[44:47] offset:1024
    v_mfma_f32_16x16x32_bf16 v[116:119], a[224:227], a[8:11], v[116:119]
    v_add_f32 v31, v31, v110
    v_fma_f32 v111, v111, s27, v25
    v_mfma_f32_16x16x32_bf16 v[116:119], a[228:231], a[12:15], v[116:119]
    s_waitcnt lgkmcnt(2)
    v_exp_f32 v111, v111
    v_mfma_f32_16x16x32_bf16 v[116:119], a[208:211], a[16:19], v[116:119]
    v_cvt_pk_bf16_f32 v63, v110, v111
    v_add_f32 v31, v31, v111
    v_mfma_f32_16x16x32_bf16 v[116:119], a[212:215], a[20:23], v[116:119]
    ds_write_b128 v7, v[48:51] offset:2048
    v_mfma_f32_16x16x32_bf16 v[116:119], a[216:219], a[24:27], v[116:119]
    buffer_load_dwordx4 v17, s[12:15], s22 offen offset:2048 lds
    v_mfma_f32_16x16x32_bf16 v[116:119], a[220:223], a[28:31], v[116:119]
    v_mfma_f32_16x16x32_bf16 v[124:127], a[248:251], a[32:35], 0
    v_mfma_f32_16x16x32_bf16 v[124:127], a[252:255], a[36:39], v[124:127]
    ds_write_b128 v7, v[52:55] offset:3072
    v_mfma_f32_16x16x32_bf16 v[124:127], a[224:227], a[40:43], v[124:127]
    v_mfma_f32_16x16x32_bf16 v[124:127], a[228:231], a[44:47], v[124:127]
    v_mfma_f32_16x16x32_bf16 v[124:127], a[208:211], a[48:51], v[124:127]
    buffer_load_dwordx4 v18, s[12:15], s22 offen offset:3072 lds
    v_mfma_f32_16x16x32_bf16 v[124:127], a[212:215], a[52:55], v[124:127]
    ds_write_b128 v7, v[56:59] offset:4096
    v_mfma_f32_16x16x32_bf16 v[124:127], a[216:219], a[56:59], v[124:127]
    v_fma_f32 v112, v112, s27, v20
    v_fma_f32 v113, v113, s27, v20
    v_mfma_f32_16x16x32_bf16 v[124:127], a[220:223], a[60:63], v[124:127]
    v_exp_f32 v112, v112
    v_mfma_f32_16x16x32_bf16 v[132:135], a[248:251], a[64:67], 0
    v_exp_f32 v113, v113
    v_mfma_f32_16x16x32_bf16 v[132:135], a[252:255], a[68:71], v[132:135]
    ds_write_b128 v7, v[60:63] offset:5120
    v_mfma_f32_16x16x32_bf16 v[132:135], a[224:227], a[72:75], v[132:135]
    v_add_f32 v26, v26, v112
    v_fma_f32 v114, v114, s27, v20
    v_mfma_f32_16x16x32_bf16 v[132:135], a[228:231], a[76:79], v[132:135]
    v_exp_f32 v114, v114
    v_mfma_f32_16x16x32_bf16 v[132:135], a[208:211], a[80:83], v[132:135]
    v_add_f32 v26, v26, v113
    v_fma_f32 v115, v115, s27, v20
    v_mfma_f32_16x16x32_bf16 v[132:135], a[212:215], a[84:87], v[132:135]
    v_exp_f32 v115, v115
    v_mfma_f32_16x16x32_bf16 v[132:135], a[216:219], a[88:91], v[132:135]
    s_add_u32 m0, s21, 20480
    v_add_f32 v26, v26, v114
    v_fma_f32 v116, v116, s27, v20
    v_mfma_f32_16x16x32_bf16 v[132:135], a[220:223], a[92:95], v[132:135]
    s_add_u32 s22, s97, s92
    v_exp_f32 v116, v116
    v_mfma_f32_16x16x32_bf16 v[140:143], a[248:251], a[96:99], 0
    buffer_load_dwordx4 v11, s[8:11], s22 offen lds
    v_mfma_f32_16x16x32_bf16 v[140:143], a[252:255], a[100:103], v[140:143]
    v_add_f32 v26, v26, v115
    v_fma_f32 v117, v117, s27, v20
    v_mfma_f32_16x16x32_bf16 v[140:143], a[224:227], a[104:107], v[140:143]
    v_exp_f32 v117, v117
    v_mfma_f32_16x16x32_bf16 v[140:143], a[228:231], a[108:111], v[140:143]
    v_add_f32 v26, v26, v116
    v_fma_f32 v118, v118, s27, v20
    v_mfma_f32_16x16x32_bf16 v[140:143], a[208:211], a[112:115], v[140:143]
    v_exp_f32 v118, v118
    v_mfma_f32_16x16x32_bf16 v[140:143], a[212:215], a[116:119], v[140:143]
    buffer_load_dwordx4 v12, s[8:11], s22 offen offset:1024 lds
    v_mfma_f32_16x16x32_bf16 v[140:143], a[216:219], a[120:123], v[140:143]
    v_add_f32 v26, v26, v117
    v_fma_f32 v119, v119, s27, v20
    v_mfma_f32_16x16x32_bf16 v[140:143], a[220:223], a[124:127], v[140:143]
    v_exp_f32 v119, v119
    v_mfma_f32_16x16x32_bf16 v[148:151], a[248:251], a[128:131], 0
    v_add_f32 v26, v26, v118
    v_fma_f32 v120, v120, s27, v21
    v_mfma_f32_16x16x32_bf16 v[148:151], a[252:255], a[132:135], v[148:151]
    v_exp_f32 v120, v120
    v_mfma_f32_16x16x32_bf16 v[148:151], a[224:227], a[136:139], v[148:151]
    buffer_load_dwordx4 v13, s[8:11], s22 offen offset:2048 lds
    v_mfma_f32_16x16x32_bf16 v[148:151], a[228:231], a[140:143], v[148:151]
    v_add_f32 v26, v26, v119
    v_add_f32 v27, v27, v120
    v_mfma_f32_16x16x32_bf16 v[148:151], a[208:211], a[144:147], v[148:151]
    v_fma_f32 v121, v121, s27, v21
    v_fma_f32 v122, v122, s27, v21
    v_mfma_f32_16x16x32_bf16 v[148:151], a[212:215], a[148:151], v[148:151]
    v_exp_f32 v121, v121
    v_mfma_f32_16x16x32_bf16 v[148:151], a[216:219], a[152:155], v[148:151]
    v_exp_f32 v122, v122
    v_mfma_f32_16x16x32_bf16 v[148:151], a[220:223], a[156:159], v[148:151]
    buffer_load_dwordx4 v14, s[8:11], s22 offen offset:3072 lds
    v_mfma_f32_16x16x32_bf16 v[156:159], a[248:251], a[160:163], 0
    v_add_f32 v27, v27, v121
    v_fma_f32 v123, v123, s27, v21
    v_mfma_f32_16x16x32_bf16 v[156:159], a[252:255], a[164:167], v[156:159]
    v_exp_f32 v123, v123
    v_mfma_f32_16x16x32_bf16 v[156:159], a[224:227], a[168:171], v[156:159]
    v_add_f32 v27, v27, v122
    v_fma_f32 v124, v124, s27, v21
    v_mfma_f32_16x16x32_bf16 v[156:159], a[228:231], a[172:175], v[156:159]
    v_exp_f32 v124, v124
    v_mfma_f32_16x16x32_bf16 v[156:159], a[208:211], a[176:179], v[156:159]
    s_add_u32 m0, s21, 24576
    v_add_f32 v27, v27, v123
    v_fma_f32 v125, v125, s27, v21
    v_mfma_f32_16x16x32_bf16 v[156:159], a[212:215], a[180:183], v[156:159]
    s_add_u32 s22, s98, s92
    v_exp_f32 v125, v125
    v_mfma_f32_16x16x32_bf16 v[156:159], a[216:219], a[184:187], v[156:159]
    buffer_load_dwordx4 v11, s[8:11], s22 offen lds
    v_mfma_f32_16x16x32_bf16 v[156:159], a[220:223], a[188:191], v[156:159]
    v_add_f32 v27, v27, v124
    v_fma_f32 v126, v126, s27, v21
    v_mfma_f32_16x16x32_bf16 v[160:163], a[192:195], v[40:43], v[160:163]
    s_waitcnt vmcnt(21)
    ds_read_b64_tr_b16 a[208:209], v3 offset:4096
    ds_read_b64_tr_b16 a[210:211], v3 offset:6144
    v_mfma_f32_16x16x32_bf16 v[164:167], a[196:199], v[40:43], v[164:167]
    v_exp_f32 v126, v126
    v_mfma_f32_16x16x32_bf16 v[168:171], a[200:203], v[40:43], v[168:171]
    v_add_f32 v27, v27, v125
    v_fma_f32 v127, v127, s27, v21
    v_mfma_f32_16x16x32_bf16 v[172:175], a[204:207], v[40:43], v[172:175]
    ds_read_b64_tr_b16 a[212:213], v4 offset:4096
    ds_read_b64_tr_b16 a[214:215], v4 offset:6144
    v_mfma_f32_16x16x32_bf16 v[176:179], a[192:195], v[44:47], v[176:179]
    buffer_load_dwordx4 v12, s[8:11], s22 offen offset:1024 lds
    v_mfma_f32_16x16x32_bf16 v[180:183], a[196:199], v[44:47], v[180:183]
    v_exp_f32 v127, v127
    v_mfma_f32_16x16x32_bf16 v[184:187], a[200:203], v[44:47], v[184:187]
    ds_read_b64_tr_b16 a[216:217], v5 offset:4096
    ds_read_b64_tr_b16 a[218:219], v5 offset:6144
    v_mfma_f32_16x16x32_bf16 v[188:191], a[204:207], v[44:47], v[188:191]
    v_cvt_pk_bf16_f32 v40, v112, v113
    v_cvt_pk_bf16_f32 v41, v114, v115
    v_mfma_f32_16x16x32_bf16 v[192:195], a[192:195], v[48:51], v[192:195]
    buffer_load_dwordx4 v13, s[8:11], s22 offen offset:2048 lds
    v_mfma_f32_16x16x32_bf16 v[196:199], a[196:199], v[48:51], v[196:199]
    ds_read_b64_tr_b16 a[220:221], v6 offset:4096
    ds_read_b64_tr_b16 a[222:223], v6 offset:6144
    v_mfma_f32_16x16x32_bf16 v[200:203], a[200:203], v[48:51], v[200:203]
    v_cvt_pk_bf16_f32 v42, v116, v117
    v_cvt_pk_bf16_f32 v43, v118, v119
    v_mfma_f32_16x16x32_bf16 v[204:207], a[204:207], v[48:51], v[204:207]
    v_cvt_pk_bf16_f32 v44, v120, v121
    v_cvt_pk_bf16_f32 v45, v122, v123
    v_mfma_f32_16x16x32_bf16 v[208:211], a[192:195], v[52:55], v[208:211]
    v_cvt_pk_bf16_f32 v46, v124, v125
    v_cvt_pk_bf16_f32 v47, v126, v127
    v_mfma_f32_16x16x32_bf16 v[212:215], a[196:199], v[52:55], v[212:215]
    buffer_load_dwordx4 v14, s[8:11], s22 offen offset:3072 lds
    v_mfma_f32_16x16x32_bf16 v[216:219], a[200:203], v[52:55], v[216:219]
    v_add_f32 v27, v27, v126
    v_fma_f32 v128, v128, s27, v22
    v_mfma_f32_16x16x32_bf16 v[220:223], a[204:207], v[52:55], v[220:223]
    s_waitcnt lgkmcnt(2)
    s_barrier
    v_mfma_f32_16x16x32_bf16 v[224:227], a[192:195], v[56:59], v[224:227]
    ds_read_b128 a[224:227], v8 offset:0
    ds_read_b128 a[228:231], v8 offset:1024
    v_mfma_f32_16x16x32_bf16 v[228:231], a[196:199], v[56:59], v[228:231]
    v_exp_f32 v128, v128
    v_mfma_f32_16x16x32_bf16 v[232:235], a[200:203], v[56:59], v[232:235]
    s_add_u32 m0, s21, 28672
    v_add_f32 v27, v27, v127
    v_add_f32 v28, v28, v128
    v_mfma_f32_16x16x32_bf16 v[236:239], a[204:207], v[56:59], v[236:239]
    s_add_u32 s22, s99, s92
    ds_read_b128 a[232:235], v8 offset:2048
    ds_read_b128 a[236:239], v8 offset:3072
    v_mfma_f32_16x16x32_bf16 v[240:243], a[192:195], v[60:63], v[240:243]
    buffer_load_dwordx4 v11, s[8:11], s22 offen lds
    v_mfma_f32_16x16x32_bf16 v[244:247], a[196:199], v[60:63], v[244:247]
    v_fma_f32 v129, v129, s27, v22
    v_fma_f32 v130, v130, s27, v22
    v_mfma_f32_16x16x32_bf16 v[248:251], a[200:203], v[60:63], v[248:251]
    v_exp_f32 v129, v129
    v_mfma_f32_16x16x32_bf16 v[252:255], a[204:207], v[60:63], v[252:255]
    s_waitcnt lgkmcnt(3)
    v_exp_f32 v130, v130
    v_mfma_f32_16x16x32_bf16 v[160:163], a[208:211], a[224:227], v[160:163]
    ds_read_b128 a[240:243], v8 offset:4096
    ds_read_b128 a[244:247], v8 offset:5120
    v_mfma_f32_16x16x32_bf16 v[164:167], a[212:215], a[224:227], v[164:167]
    buffer_load_dwordx4 v12, s[8:11], s22 offen offset:1024 lds
    v_mfma_f32_16x16x32_bf16 v[168:171], a[216:219], a[224:227], v[168:171]
    s_waitcnt vmcnt(22)
    ds_read_b64_tr_b16 a[192:193], v3 offset:8192
    ds_read_b64_tr_b16 a[194:195], v3 offset:10240
    v_mfma_f32_16x16x32_bf16 v[172:175], a[220:223], a[224:227], v[172:175]
    s_waitcnt lgkmcnt(4)
    v_cvt_pk_bf16_f32 v48, v128, v129
    v_add_f32 v28, v28, v129
    v_mfma_f32_16x16x32_bf16 v[176:179], a[208:211], a[228:231], v[176:179]
    v_add_f32 v28, v28, v130
    v_fma_f32 v131, v131, s27, v22
    v_mfma_f32_16x16x32_bf16 v[180:183], a[212:215], a[228:231], v[180:183]
    v_exp_f32 v131, v131
    v_mfma_f32_16x16x32_bf16 v[184:187], a[216:219], a[228:231], v[184:187]
    ds_read_b64_tr_b16 a[196:197], v4 offset:8192
    ds_read_b64_tr_b16 a[198:199], v4 offset:10240
    v_mfma_f32_16x16x32_bf16 v[188:191], a[220:223], a[228:231], v[188:191]
    buffer_load_dwordx4 v13, s[8:11], s22 offen offset:2048 lds
    v_mfma_f32_16x16x32_bf16 v[192:195], a[208:211], a[232:235], v[192:195]
    ds_read_b128 a[248:251], v9 offset:0
    ds_read_b128 a[252:255], v9 offset:1024
    v_mfma_f32_16x16x32_bf16 v[196:199], a[212:215], a[232:235], v[196:199]
    v_cvt_pk_bf16_f32 v49, v130, v131
    v_add_f32 v28, v28, v131
    v_mfma_f32_16x16x32_bf16 v[200:203], a[216:219], a[232:235], v[200:203]
    ds_read_b64_tr_b16 a[200:201], v5 offset:8192
    ds_read_b64_tr_b16 a[202:203], v5 offset:10240
    v_mfma_f32_16x16x32_bf16 v[204:207], a[220:223], a[232:235], v[204:207]
    buffer_load_dwordx4 v14, s[8:11], s22 offen offset:3072 lds
    v_mfma_f32_16x16x32_bf16 v[208:211], a[208:211], a[236:239], v[208:211]
    v_fma_f32 v132, v132, s27, v22
    v_fma_f32 v133, v133, s27, v22
    v_mfma_f32_16x16x32_bf16 v[212:215], a[212:215], a[236:239], v[212:215]
    v_exp_f32 v132, v132
    v_mfma_f32_16x16x32_bf16 v[216:219], a[216:219], a[236:239], v[216:219]
    ds_read_b64_tr_b16 a[204:205], v6 offset:8192
    ds_read_b64_tr_b16 a[206:207], v6 offset:10240
    v_mfma_f32_16x16x32_bf16 v[220:223], a[220:223], a[236:239], v[220:223]
    s_waitcnt lgkmcnt(6)
    v_exp_f32 v133, v133
    v_mfma_f32_16x16x32_bf16 v[224:227], a[208:211], a[240:243], v[224:227]
    s_add_u32 m0, s21, 4096
    ds_read_b128 a[224:227], v9 offset:2048
    ds_read_b128 a[228:231], v9 offset:3072
    v_mfma_f32_16x16x32_bf16 v[228:231], a[212:215], a[240:243], v[228:231]
    s_add_u32 s22, s24, s91
    v_cvt_pk_bf16_f32 v50, v132, v133
    v_add_f32 v28, v28, v132
    v_mfma_f32_16x16x32_bf16 v[232:235], a[216:219], a[240:243], v[232:235]
    buffer_load_dwordx4 v15, s[12:15], s22 offen lds
    v_mfma_f32_16x16x32_bf16 v[236:239], a[220:223], a[240:243], v[236:239]
    v_add_f32 v28, v28, v133
    v_fma_f32 v134, v134, s27, v22
    v_mfma_f32_16x16x32_bf16 v[240:243], a[208:211], a[244:247], v[240:243]
    v_exp_f32 v134, v134
    v_mfma_f32_16x16x32_bf16 v[244:247], a[212:215], a[244:247], v[244:247]
    v_add_f32 v28, v28, v134
    v_fma_f32 v135, v135, s27, v22
    v_mfma_f32_16x16x32_bf16 v[248:251], a[216:219], a[244:247], v[248:251]
    v_exp_f32 v135, v135
    v_mfma_f32_16x16x32_bf16 v[252:255], a[220:223], a[244:247], v[252:255]
    s_waitcnt lgkmcnt(2)
    buffer_load_dwordx4 v16, s[12:15], s22 offen offset:1024 lds
    v_mfma_f32_16x16x32_bf16 v[160:163], a[192:195], a[248:251], v[160:163]
    ds_read_b128 a[232:235], v9 offset:4096
    ds_read_b128 a[236:239], v9 offset:5120
    v_mfma_f32_16x16x32_bf16 v[164:167], a[196:199], a[248:251], v[164:167]
    v_cvt_pk_bf16_f32 v51, v134, v135
    v_add_f32 v28, v28, v135
    v_mfma_f32_16x16x32_bf16 v[168:171], a[200:203], a[248:251], v[168:171]
    s_waitcnt vmcnt(22)
    ds_read_b64_tr_b16 a[208:209], v3 offset:12288
    ds_read_b64_tr_b16 a[210:211], v3 offset:14336
    v_mfma_f32_16x16x32_bf16 v[172:175], a[204:207], a[248:251], v[172:175]
    v_fma_f32 v136, v136, s27, v23
    v_fma_f32 v137, v137, s27, v23
    v_mfma_f32_16x16x32_bf16 v[176:179], a[192:195], a[252:255], v[176:179]
    buffer_load_dwordx4 v17, s[12:15], s22 offen offset:2048 lds
    v_mfma_f32_16x16x32_bf16 v[180:183], a[196:199], a[252:255], v[180:183]
    v_exp_f32 v136, v136
    v_mfma_f32_16x16x32_bf16 v[184:187], a[200:203], a[252:255], v[184:187]
    ds_read_b64_tr_b16 a[212:213], v4 offset:12288
    ds_read_b64_tr_b16 a[214:215], v4 offset:14336
    v_mfma_f32_16x16x32_bf16 v[188:191], a[204:207], a[252:255], v[188:191]
    s_waitcnt lgkmcnt(6)
    v_exp_f32 v137, v137
    v_mfma_f32_16x16x32_bf16 v[192:195], a[192:195], a[224:227], v[192:195]
    ds_read_b128 a[240:243], v10 offset:0
    ds_read_b128 a[244:247], v10 offset:1024
    v_mfma_f32_16x16x32_bf16 v[196:199], a[196:199], a[224:227], v[196:199]
    buffer_load_dwordx4 v18, s[12:15], s22 offen offset:3072 lds
    v_mfma_f32_16x16x32_bf16 v[200:203], a[200:203], a[224:227], v[200:203]
    ds_read_b64_tr_b16 a[216:217], v5 offset:12288
    ds_read_b64_tr_b16 a[218:219], v5 offset:14336
    v_mfma_f32_16x16x32_bf16 v[204:207], a[204:207], a[224:227], v[204:207]
    v_cvt_pk_bf16_f32 v52, v136, v137
    v_add_f32 v29, v29, v136
    v_mfma_f32_16x16x32_bf16 v[208:211], a[192:195], a[228:231], v[208:211]
    v_add_f32 v29, v29, v137
    v_fma_f32 v138, v138, s27, v23
    v_mfma_f32_16x16x32_bf16 v[212:215], a[196:199], a[228:231], v[212:215]
    s_add_u32 s22, s25, s91
    v_exp_f32 v138, v138
    v_mfma_f32_16x16x32_bf16 v[216:219], a[200:203], a[228:231], v[216:219]
    s_add_u32 m0, s21, 8192
    ds_read_b64_tr_b16 a[220:221], v6 offset:12288
    ds_read_b64_tr_b16 a[222:223], v6 offset:14336
    v_mfma_f32_16x16x32_bf16 v[220:223], a[204:207], a[228:231], v[220:223]
    s_waitcnt lgkmcnt(6)
    v_add_f32 v29, v29, v138
    v_fma_f32 v139, v139, s27, v23
    v_mfma_f32_16x16x32_bf16 v[224:227], a[192:195], a[232:235], v[224:227]
    ds_read_b128 a[248:251], v10 offset:2048
    ds_read_b128 a[252:255], v10 offset:3072
    v_mfma_f32_16x16x32_bf16 v[228:231], a[196:199], a[232:235], v[228:231]
    buffer_load_dwordx4 v15, s[12:15], s22 offen lds
    v_mfma_f32_16x16x32_bf16 v[232:235], a[200:203], a[232:235], v[232:235]
    v_exp_f32 v139, v139
    v_mfma_f32_16x16x32_bf16 v[236:239], a[204:207], a[232:235], v[236:239]
    v_cvt_pk_bf16_f32 v53, v138, v139
    v_add_f32 v29, v29, v139
    v_mfma_f32_16x16x32_bf16 v[240:243], a[192:195], a[236:239], v[240:243]
    v_fma_f32 v140, v140, s27, v23
    v_fma_f32 v141, v141, s27, v23
    v_mfma_f32_16x16x32_bf16 v[244:247], a[196:199], a[236:239], v[244:247]
    buffer_load_dwordx4 v16, s[12:15], s22 offen offset:1024 lds
    v_mfma_f32_16x16x32_bf16 v[248:251], a[200:203], a[236:239], v[248:251]
    v_exp_f32 v140, v140
    v_mfma_f32_16x16x32_bf16 v[252:255], a[204:207], a[236:239], v[252:255]
    s_waitcnt lgkmcnt(2)
    v_exp_f32 v141, v141
    v_mfma_f32_16x16x32_bf16 v[160:163], a[208:211], a[240:243], v[160:163]
    ds_read_b128 a[224:227], v10 offset:4096
    ds_read_b128 a[228:231], v10 offset:5120
    v_mfma_f32_16x16x32_bf16 v[164:167], a[212:215], a[240:243], v[164:167]
    v_cvt_pk_bf16_f32 v54, v140, v141
    v_add_f32 v29, v29, v140
    v_mfma_f32_16x16x32_bf16 v[168:171], a[216:219], a[240:243], v[168:171]
    buffer_load_dwordx4 v17, s[12:15], s22 offen offset:2048 lds
    v_mfma_f32_16x16x32_bf16 v[172:175], a[220:223], a[240:243], v[172:175]
    v_add_f32 v29, v29, v141
    v_fma_f32 v142, v142, s27, v23
    v_mfma_f32_16x16x32_bf16 v[176:179], a[208:211], a[244:247], v[176:179]
    v_exp_f32 v142, v142
    v_mfma_f32_16x16x32_bf16 v[180:183], a[212:215], a[244:247], v[180:183]
    v_add_f32 v29, v29, v142
    v_fma_f32 v143, v143, s27, v23
    v_mfma_f32_16x16x32_bf16 v[184:187], a[216:219], a[244:247], v[184:187]
    v_exp_f32 v143, v143
    v_mfma_f32_16x16x32_bf16 v[188:191], a[220:223], a[244:247], v[188:191]
    s_waitcnt lgkmcnt(2)
    buffer_load_dwordx4 v18, s[12:15], s22 offen offset:3072 lds
    v_mfma_f32_16x16x32_bf16 v[192:195], a[208:211], a[248:251], v[192:195]
    s_waitcnt vmcnt(16)
    ds_read_b128 a[192:195], v1 offset:16384
    ds_read_b128 a[196:199], v2 offset:16384
    v_mfma_f32_16x16x32_bf16 v[196:199], a[212:215], a[248:251], v[196:199]
    v_cvt_pk_bf16_f32 v55, v142, v143
    v_add_f32 v29, v29, v143
    v_mfma_f32_16x16x32_bf16 v[200:203], a[216:219], a[248:251], v[200:203]
    ds_read_b128 a[200:203], v35 offset:16384
    ds_read_b128 a[204:207], v39 offset:16384
    v_mfma_f32_16x16x32_bf16 v[204:207], a[220:223], a[248:251], v[204:207]
    v_fma_f32 v144, v144, s27, v24
    v_fma_f32 v145, v145, s27, v24
    v_mfma_f32_16x16x32_bf16 v[208:211], a[208:211], a[252:255], v[208:211]
    s_add_u32 m0, s21, 12288
    ds_read_b128 a[232:235], v1 offset:16640
    ds_read_b128 a[236:239], v2 offset:16640
    v_mfma_f32_16x16x32_bf16 v[212:215], a[212:215], a[252:255], v[212:215]
    s_add_u32 s22, s26, s91
    v_exp_f32 v144, v144
    v_mfma_f32_16x16x32_bf16 v[216:219], a[216:219], a[252:255], v[216:219]
    ds_read_b128 a[240:243], v35 offset:16640
    ds_read_b128 a[244:247], v39 offset:16640
    v_mfma_f32_16x16x32_bf16 v[220:223], a[220:223], a[252:255], v[220:223]
    s_waitcnt lgkmcnt(8)
    buffer_load_dwordx4 v15, s[12:15], s22 offen lds
    v_mfma_f32_16x16x32_bf16 v[224:227], a[208:211], a[224:227], v[224:227]
    v_exp_f32 v145, v145
    v_mfma_f32_16x16x32_bf16 v[228:231], a[212:215], a[224:227], v[228:231]
    v_cvt_pk_bf16_f32 v56, v144, v145
    v_add_f32 v30, v30, v144
    v_mfma_f32_16x16x32_bf16 v[232:235], a[216:219], a[224:227], v[232:235]
    v_add_f32 v30, v30, v145
    v_fma_f32 v146, v146, s27, v24
    v_mfma_f32_16x16x32_bf16 v[236:239], a[220:223], a[224:227], v[236:239]
    buffer_load_dwordx4 v16, s[12:15], s22 offen offset:1024 lds
    v_mfma_f32_16x16x32_bf16 v[240:243], a[208:211], a[228:231], v[240:243]
    v_exp_f32 v146, v146
    v_mfma_f32_16x16x32_bf16 v[244:247], a[212:215], a[228:231], v[244:247]
    v_add_f32 v30, v30, v146
    v_fma_f32 v147, v147, s27, v24
    v_mfma_f32_16x16x32_bf16 v[248:251], a[216:219], a[228:231], v[248:251]
    v_exp_f32 v147, v147
    v_mfma_f32_16x16x32_bf16 v[252:255], a[220:223], a[228:231], v[252:255]
    s_waitcnt lgkmcnt(0)
    v_cvt_pk_bf16_f32 v57, v146, v147
    v_add_f32 v30, v30, v147
    v_mfma_f32_16x16x32_bf16 v[64:67], a[192:195], a[0:3], 0
    buffer_load_dwordx4 v17, s[12:15], s22 offen offset:2048 lds
    v_mfma_f32_16x16x32_bf16 v[64:67], a[196:199], a[4:7], v[64:67]
    ds_read_b64_tr_b16 a[208:209], v3 offset:0
    ds_read_b64_tr_b16 a[210:211], v3 offset:2048
    v_mfma_f32_16x16x32_bf16 v[64:67], a[200:203], a[8:11], v[64:67]
    v_fma_f32 v148, v148, s27, v24
    v_fma_f32 v149, v149, s27, v24
    v_mfma_f32_16x16x32_bf16 v[64:67], a[204:207], a[12:15], v[64:67]
    ds_read_b64_tr_b16 a[212:213], v4 offset:0
    ds_read_b64_tr_b16 a[214:215], v4 offset:2048
    v_mfma_f32_16x16x32_bf16 v[64:67], a[232:235], a[16:19], v[64:67]
    v_exp_f32 v148, v148
    v_mfma_f32_16x16x32_bf16 v[64:67], a[236:239], a[20:23], v[64:67]
    ds_read_b64_tr_b16 a[216:217], v5 offset:0
    ds_read_b64_tr_b16 a[218:219], v5 offset:2048
    v_mfma_f32_16x16x32_bf16 v[64:67], a[240:243], a[24:27], v[64:67]
    buffer_load_dwordx4 v18, s[12:15], s22 offen offset:3072 lds
    v_mfma_f32_16x16x32_bf16 v[64:67], a[244:247], a[28:31], v[64:67]
    ds_read_b64_tr_b16 a[220:221], v6 offset:0
    ds_read_b64_tr_b16 a[222:223], v6 offset:2048
    v_mfma_f32_16x16x32_bf16 v[72:75], a[192:195], a[32:35], 0
    v_exp_f32 v149, v149
    v_mfma_f32_16x16x32_bf16 v[72:75], a[196:199], a[36:39], v[72:75]
    v_cvt_pk_bf16_f32 v58, v148, v149
    v_add_f32 v30, v30, v148
    v_mfma_f32_16x16x32_bf16 v[72:75], a[200:203], a[40:43], v[72:75]
    s_add_u32 m0, s21, 16384
    v_add_f32 v30, v30, v149
    v_fma_f32 v150, v150, s27, v24
    v_mfma_f32_16x16x32_bf16 v[72:75], a[204:207], a[44:47], v[72:75]
    s_add_u32 s22, s96, s93
    v_exp_f32 v150, v150
    v_mfma_f32_16x16x32_bf16 v[72:75], a[232:235], a[48:51], v[72:75]
    buffer_load_dwordx4 v11, s[8:11], s22 offen lds
    v_mfma_f32_16x16x32_bf16 v[72:75], a[236:239], a[52:55], v[72:75]
    v_add_f32 v30, v30, v150
    v_fma_f32 v151, v151, s27, v24
    v_mfma_f32_16x16x32_bf16 v[72:75], a[240:243], a[56:59], v[72:75]
    v_exp_f32 v151, v151
    v_mfma_f32_16x16x32_bf16 v[72:75], a[244:247], a[60:63], v[72:75]
    v_cvt_pk_bf16_f32 v59, v150, v151
    v_add_f32 v30, v30, v151
    v_mfma_f32_16x16x32_bf16 v[80:83], a[192:195], a[64:67], 0
    v_fma_f32 v152, v152, s27, v25
    v_fma_f32 v153, v153, s27, v25
    v_mfma_f32_16x16x32_bf16 v[80:83], a[196:199], a[68:71], v[80:83]
    v_exp_f32 v152, v152
    v_mfma_f32_16x16x32_bf16 v[80:83], a[200:203], a[72:75], v[80:83]
    v_exp_f32 v153, v153
    v_mfma_f32_16x16x32_bf16 v[80:83], a[204:207], a[76:79], v[80:83]
    buffer_load_dwordx4 v12, s[8:11], s22 offen offset:1024 lds
    v_mfma_f32_16x16x32_bf16 v[80:83], a[232:235], a[80:83], v[80:83]
    v_cvt_pk_bf16_f32 v60, v152, v153
    v_add_f32 v31, v31, v152
    v_mfma_f32_16x16x32_bf16 v[80:83], a[236:239], a[84:87], v[80:83]
    v_add_f32 v31, v31, v153
    v_fma_f32 v154, v154, s27, v25
    v_mfma_f32_16x16x32_bf16 v[80:83], a[240:243], a[88:91], v[80:83]
    v_exp_f32 v154, v154
    v_mfma_f32_16x16x32_bf16 v[80:83], a[244:247], a[92:95], v[80:83]
    v_add_f32 v31, v31, v154
    v_fma_f32 v155, v155, s27, v25
    v_mfma_f32_16x16x32_bf16 v[88:91], a[192:195], a[96:99], 0
    v_exp_f32 v155, v155
    v_mfma_f32_16x16x32_bf16 v[88:91], a[196:199], a[100:103], v[88:91]
    v_cvt_pk_bf16_f32 v61, v154, v155
    v_add_f32 v31, v31, v155
    v_mfma_f32_16x16x32_bf16 v[88:91], a[200:203], a[104:107], v[88:91]
    s_waitcnt vmcnt(14)
    ds_read_b128 a[248:251], v1 offset:24576
    ds_read_b128 a[252:255], v2 offset:24576
    v_mfma_f32_16x16x32_bf16 v[88:91], a[204:207], a[108:111], v[88:91]
    buffer_load_dwordx4 v13, s[8:11], s22 offen offset:2048 lds
    v_mfma_f32_16x16x32_bf16 v[88:91], a[232:235], a[112:115], v[88:91]
    ds_read_b128 a[224:227], v35 offset:24576
    ds_read_b128 a[228:231], v39 offset:24576
    v_mfma_f32_16x16x32_bf16 v[88:91], a[236:239], a[116:119], v[88:91]
    v_fma_f32 v156, v156, s27, v25
    v_fma_f32 v157, v157, s27, v25
    v_mfma_f32_16x16x32_bf16 v[88:91], a[240:243], a[120:123], v[88:91]
    v_exp_f32 v156, v156
    v_mfma_f32_16x16x32_bf16 v[88:91], a[244:247], a[124:127], v[88:91]
    v_exp_f32 v157, v157
    v_mfma_f32_16x16x32_bf16 v[96:99], a[192:195], a[128:131], 0
    v_cvt_pk_bf16_f32 v62, v156, v157
    v_add_f32 v31, v31, v156
    v_mfma_f32_16x16x32_bf16 v[96:99], a[196:199], a[132:135], v[96:99]
    buffer_load_dwordx4 v14, s[8:11], s22 offen offset:3072 lds
    v_mfma_f32_16x16x32_bf16 v[96:99], a[200:203], a[136:139], v[96:99]
L_iw3:
    s_cbranch_execz L_iwdone
    v_add_f32 v31, v31, v157
    v_fma_f32 v158, v158, s27, v25
    v_mfma_f32_16x16x32_bf16 v[96:99], a[204:207], a[140:143], v[96:99]
    v_exp_f32 v158, v158
    v_mfma_f32_16x16x32_bf16 v[96:99], a[232:235], a[144:147], v[96:99]
    v_add_f32 v31, v31, v158
    v_fma_f32 v159, v159, s27, v25
    v_mfma_f32_16x16x32_bf16 v[96:99], a[236:239], a[148:151], v[96:99]
    v_exp_f32 v159, v159
    v_mfma_f32_16x16x32_bf16 v[96:99], a[240:243], a[152:155], v[96:99]
    s_add_u32 m0, s21, 0
    v_cvt_pk_bf16_f32 v63, v158, v159
    v_add_f32 v31, v31, v159
    v_mfma_f32_16x16x32_bf16 v[96:99], a[244:247], a[156:159], v[96:99]
    s_add_u32 s22, s23, s92
    v_mfma_f32_16x16x32_bf16 v[104:107], a[192:195], a[160:163], 0
    s_waitcnt lgkmcnt(0)
    buffer_load_dwordx4 v15, s[12:15], s22 offen lds
    v_mfma_f32_16x16x32_bf16 v[104:107], a[196:199], a[164:167], v[104:107]
    ds_read_b128 a[192:195], v1 offset:24832
    ds_read_b128 a[196:199], v2 offset:24832
    v_mfma_f32_16x16x32_bf16 v[104:107], a[200:203], a[168:171], v[104:107]
    v_mfma_f32_16x16x32_bf16 v[104:107], a[204:207], a[172:175], v[104:107]
    ds_read_b128 a[200:203], v35 offset:24832
    ds_read_b128 a[204:207], v39 offset:24832
    v_mfma_f32_16x16x32_bf16 v[104:107], a[232:235], a[176:179], v[104:107]
    s_barrier
    v_mfma_f32_16x16x32_bf16 v[104:107], a[236:239], a[180:183], v[104:107]
    ds_write_b128 v7, v[40:43] offset:0
    v_mfma_f32_16x16x32_bf16 v[104:107], a[240:243], a[184:187], v[104:107]
    v_mfma_f32_16x16x32_bf16 v[104:107], a[244:247], a[188:191], v[104:107]
    buffer_load_dwordx4 v16, s[12:15], s22 offen offset:1024 lds
    v_mfma_f32_16x16x32_bf16 v[68:71], a[248:251], a[0:3], 0
    v_mfma_f32_16x16x32_bf16 v[68:71], a[252:255], a[4:7], v[68:71]
    ds_write_b128 v7, v[44:47] offset:1024
    v_mfma_f32_16x16x32_bf16 v[68:71], a[224:227], a[8:11], v[68:71]
    v_mfma_f32_16x16x32_bf16 v[68:71], a[228:231], a[12:15], v[68:71]
    s_waitcnt lgkmcnt(2)
    v_mfma_f32_16x16x32_bf16 v[68:71], a[192:195], a[16:19], v[68:71]
    v_mfma_f32_16x16x32_bf16 v[68:71], a[196:199], a[20:23], v[68:71]
    ds_write_b128 v7, v[48:51] offset:2048
    v_mfma_f32_16x16x32_bf16 v[68:71], a[200:203], a[24:27], v[68:71]
    buffer_load_dwordx4 v17, s[12:15], s22 offen offset:2048 lds
    v_mfma_f32_16x16x32_bf16 v[68:71], a[204:207], a[28:31], v[68:71]
    v_mfma_f32_16x16x32_bf16 v[76:79], a[248:251], a[32:35], 0
    v_mfma_f32_16x16x32_bf16 v[76:79], a[252:255], a[36:39], v[76:79]
    ds_write_b128 v7, v[52:55] offset:3072
    v_mfma_f32_16x16x32_bf16 v[76:79], a[224:227], a[40:43], v[76:79]
    v_mfma_f32_16x16x32_bf16 v[76:79], a[228:231], a[44:47], v[76:79]
    v_mfma_f32_16x16x32_bf16 v[76:79], a[192:195], a[48:51], v[76:79]
    v_mfma_f32_16x16x32_bf16 v[76:79], a[196:199], a[52:55], v[76:79]
    buffer_load_dwordx4 v18, s[12:15], s22 offen offset:3072 lds
    v_mfma_f32_16x16x32_bf16 v[76:79], a[200:203], a[56:59], v[76:79]
    ds_write_b128 v7, v[56:59] offset:4096
    v_mfma_f32_16x16x32_bf16 v[76:79], a[204:207], a[60:63], v[76:79]
    v_fma_f32 v64, v64, s27, v20
    v_fma_f32 v65, v65, s27, v20
    v_mfma_f32_16x16x32_bf16 v[84:87], a[248:251], a[64:67], 0
    v_exp_f32 v64, v64
    v_mfma_f32_16x16x32_bf16 v[84:87], a[252:255], a[68:71], v[84:87]
    v_exp_f32 v65, v65
    v_mfma_f32_16x16x32_bf16 v[84:87], a[224:227], a[72:75], v[84:87]
    ds_write_b128 v7, v[60:63] offset:5120
    v_mfma_f32_16x16x32_bf16 v[84:87], a[228:231], a[76:79], v[84:87]
    v_add_f32 v26, v26, v64
    v_fma_f32 v66, v66, s27, v20
    v_mfma_f32_16x16x32_bf16 v[84:87], a[192:195], a[80:83], v[84:87]
    v_exp_f32 v66, v66
    v_mfma_f32_16x16x32_bf16 v[84:87], a[196:199], a[84:87], v[84:87]
    v_add_f32 v26, v26, v65
    v_fma_f32 v67, v67, s27, v20
    v_mfma_f32_16x16x32_bf16 v[84:87], a[200:203], a[88:91], v[84:87]
    s_add_u32 m0, s21, 20480
    v_exp_f32 v67, v67
    v_mfma_f32_16x16x32_bf16 v[84:87], a[204:207], a[92:95], v[84:87]
    s_add_u32 s22, s97, s93
    v_add_f32 v26, v26, v66
    v_fma_f32 v68, v68, s27, v20
    v_mfma_f32_16x16x32_bf16 v[92:95], a[248:251], a[96:99], 0
    buffer_load_dwordx4 v11, s[8:11], s22 offen lds
    v_mfma_f32_16x16x32_bf16 v[92:95], a[252:255], a[100:103], v[92:95]
    v_exp_f32 v68, v68
    v_mfma_f32_16x16x32_bf16 v[92:95], a[224:227], a[104:107], v[92:95]
    v_add_f32 v26, v26, v67
    v_fma_f32 v69, v69, s27, v20
    v_mfma_f32_16x16x32_bf16 v[92:95], a[228:231], a[108:111], v[92:95]
    v_exp_f32 v69, v69
    v_mfma_f32_16x16x32_bf16 v[92:95], a[192:195], a[112:115], v[92:95]
    v_add_f32 v26, v26, v68
    v_fma_f32 v70, v70, s27, v20
    v_mfma_f32_16x16x32_bf16 v[92:95], a[196:199], a[116:119], v[92:95]
    buffer_load_dwordx4 v12, s[8:11], s22 offen offset:1024 lds
    v_mfma_f32_16x16x32_bf16 v[92:95], a[200:203], a[120:123], v[92:95]
    v_exp_f32 v70, v70
    v_mfma_f32_16x16x32_bf16 v[92:95], a[204:207], a[124:127], v[92:95]
    v_add_f32 v26, v26, v69
    v_fma_f32 v71, v71, s27, v20
    v_mfma_f32_16x16x32_bf16 v[100:103], a[248:251], a[128:131], 0
    v_exp_f32 v71, v71
    v_mfma_f32_16x16x32_bf16 v[100:103], a[252:255], a[132:135], v[100:103]
    v_add_f32 v26, v26, v70
    v_fma_f32 v72, v72, s27, v21
    v_mfma_f32_16x16x32_bf16 v[100:103], a[224:227], a[136:139], v[100:103]
    buffer_load_dwordx4 v13, s[8:11], s22 offen offset:2048 lds
    v_mfma_f32_16x16x32_bf16 v[100:103], a[228:231], a[140:143], v[100:103]
    v_exp_f32 v72, v72
    v_mfma_f32_16x16x32_bf16 v[100:103], a[192:195], a[144:147], v[100:103]
    v_add_f32 v26, v26, v71
    v_add_f32 v27, v27, v72
    v_mfma_f32_16x16x32_bf16 v[100:103], a[196:199], a[148:151], v[100:103]
    v_fma_f32 v73, v73, s27, v21
    v_fma_f32 v74, v74, s27, v21
    v_mfma_f32_16x16x32_bf16 v[100:103], a[200:203], a[152:155], v[100:103]
    v_exp_f32 v73, v73
    v_mfma_f32_16x16x32_bf16 v[100:103], a[204:207], a[156:159], v[100:103]
    buffer_load_dwordx4 v14, s[8:11], s22 offen offset:3072 lds
    v_mfma_f32_16x16x32_bf16 v[108:111], a[248:251], a[160:163], 0
    v_exp_f32 v74, v74
    v_mfma_f32_16x16x32_bf16 v[108:111], a[252:255], a[164:167], v[108:111]
    v_add_f32 v27, v27, v73
    v_fma_f32 v75, v75, s27, v21
    v_mfma_f32_16x16x32_bf16 v[108:111], a[224:227], a[168:171], v[108:111]
    v_exp_f32 v75, v75
    v_mfma_f32_16x16x32_bf16 v[108:111], a[228:231], a[172:175], v[108:111]
    v_add_f32 v27, v27, v74
    v_fma_f32 v76, v76, s27, v21
    v_mfma_f32_16x16x32_bf16 v[108:111], a[192:195], a[176:179], v[108:111]
    s_add_u32 m0, s21, 24576
    v_exp_f32 v76, v76
    v_mfma_f32_16x16x32_bf16 v[108:111], a[196:199], a[180:183], v[108:111]
    s_add_u32 s22, s98, s93
    v_add_f32 v27, v27, v75
    v_fma_f32 v77, v77, s27, v21
    v_mfma_f32_16x16x32_bf16 v[108:111], a[200:203], a[184:187], v[108:111]
    buffer_load_dwordx4 v11, s[8:11], s22 offen lds
    v_mfma_f32_16x16x32_bf16 v[108:111], a[204:207], a[188:191], v[108:111]
    v_exp_f32 v77, v77
    v_mfma_f32_16x16x32_bf16 v[160:163], a[208:211], v[40:43], v[160:163]
    s_waitcnt vmcnt(21)
    ds_read_b64_tr_b16 a[192:193], v3 offset:4096
    ds_read_b64_tr_b16 a[194:195], v3 offset:6144
    v_mfma_f32_16x16x32_bf16 v[164:167], a[212:215], v[40:43], v[164:167]
    v_add_f32 v27, v27, v76
    v_fma_f32 v78, v78, s27, v21
    v_mfma_f32_16x16x32_bf16 v[168:171], a[216:219], v[40:43], v[168:171]
    v_exp_f32 v78, v78
    v_mfma_f32_16x16x32_bf16 v[172:175], a[220:223], v[40:43], v[172:175]
    ds_read_b64_tr_b16 a[196:197], v4 offset:4096
    ds_read_b64_tr_b16 a[198:199], v4 offset:6144
    v_mfma_f32_16x16x32_bf16 v[176:179], a[208:211], v[44:47], v[176:179]
    buffer_load_dwordx4 v12, s[8:11], s22 offen offset:1024 lds
    v_mfma_f32_16x16x32_bf16 v[180:183], a[212:215], v[44:47], v[180:183]
    v_cvt_pk_bf16_f32 v40, v64, v65
    v_cvt_pk_bf16_f32 v41, v66, v67
    v_mfma_f32_16x16x32_bf16 v[184:187], a[216:219], v[44:47], v[184:187]
    ds_read_b64_tr_b16 a[200:201], v5 offset:4096
    ds_read_b64_tr_b16 a[202:203], v5 offset:6144
    v_mfma_f32_16x16x32_bf16 v[188:191], a[220:223], v[44:47], v[188:191]
    v_cvt_pk_bf16_f32 v42, v68, v69
    v_cvt_pk_bf16_f32 v43, v70, v71
    v_mfma_f32_16x16x32_bf16 v[192:195], a[208:211], v[48:51], v[192:195]
    buffer_load_dwordx4 v13, s[8:11], s22 offen offset:2048 lds
    v_mfma_f32_16x16x32_bf16 v[196:199], a[212:215], v[48:51], v[196:199]
    ds_read_b64_tr_b16 a[204:205], v6 offset:4096
    ds_read_b64_tr_b16 a[206:207], v6 offset:6144
    v_mfma_f32_16x16x32_bf16 v[200:203], a[216:219], v[48:51], v[200:203]
    v_cvt_pk_bf16_f32 v44, v72, v73
    v_cvt_pk_bf16_f32 v45, v74, v75
    v_mfma_f32_16x16x32_bf16 v[204:207], a[220:223], v[48:51], v[204:207]
    v_cvt_pk_bf16_f32 v46, v76, v77
    v_add_f32 v27, v27, v77
    v_mfma_f32_16x16x32_bf16 v[208:211], a[208:211], v[52:55], v[208:211]
    v_add_f32 v27, v27, v78
    v_fma_f32 v79, v79, s27, v21
    v_mfma_f32_16x16x32_bf16 v[212:215], a[212:215], v[52:55], v[212:215]
    buffer_load_dwordx4 v14, s[8:11], s22 offen offset:3072 lds
    v_mfma_f32_16x16x32_bf16 v[216:219], a[216:219], v[52:55], v[216:219]
    v_exp_f32 v79, v79
    v_mfma_f32_16x16x32_bf16 v[220:223], a[220:223], v[52:55], v[220:223]
    s_waitcnt lgkmcnt(2)
    s_barrier
    v_mfma_f32_16x16x32_bf16 v[224:227], a[208:211], v[56:59], v[224:227]
    ds_read_b128 a[224:227], v8 offset:0
    ds_read_b128 a[228:231], v8 offset:1024
    v_mfma_f32_16x16x32_bf16 v[228:231], a[212:215], v[56:59], v[228:231]
    v_cvt_pk_bf16_f32 v47, v78, v79
    v_add_f32 v27, v27, v79
    v_mfma_f32_16x16x32_bf16 v[232:235], a[216:219], v[56:59], v[232:235]
    s_add_u32 m0, s21, 28672
    v_fma_f32 v80, v80, s27, v22
    v_fma_f32 v81, v81, s27, v22
    v_mfma_f32_16x16x32_bf16 v[236:239], a[220:223], v[56:59], v[236:239]
    s_add_u32 s22, s99, s93
    ds_read_b128 a[232:235], v8 offset:2048
    ds_read_b128 a[236:239], v8 offset:3072
    v_mfma_f32_16x16x32_bf16 v[240:243], a[208:211], v[60:63], v[240:243]
    buffer_load_dwordx4 v11, s[8:11], s22 offen lds
    v_mfma_f32_16x16x32_bf16 v[244:247], a[212:215], v[60:63], v[244:247]
    v_exp_f32 v80, v80
    v_mfma_f32_16x16x32_bf16 v[248:251], a[216:219], v[60:63], v[248:251]
    v_exp_f32 v81, v81
    v_mfma_f32_16x16x32_bf16 v[252:255], a[220:223], v[60:63], v[252:255]
    s_waitcnt lgkmcnt(3)
    v_cvt_pk_bf16_f32 v48, v80, v81
    v_add_f32 v28, v28, v80
    v_mfma_f32_16x16x32_bf16 v[160:163], a[192:195], a[224:227], v[160:163]
    ds_read_b128 a[240:243], v8 offset:4096
    ds_read_b128 a[244:247], v8 offset:5120
    v_mfma_f32_16x16x32_bf16 v[164:167], a[196:199], a[224:227], v[164:167]
    buffer_load_dwordx4 v12, s[8:11], s22 offen offset:1024 lds
    v_mfma_f32_16x16x32_bf16 v[168:171], a[200:203], a[224:227], v[168:171]
    s_waitcnt vmcnt(22)
    ds_read_b64_tr_b16 a[208:209], v3 offset:8192
    ds_read_b64_tr_b16 a[210:211], v3 offset:10240
    v_mfma_f32_16x16x32_bf16 v[172:175], a[204:207], a[224:227], v[172:175]
    s_waitcnt lgkmcnt(4)
    v_add_f32 v28, v28, v81
    v_fma_f32 v82, v82, s27, v22
    v_mfma_f32_16x16x32_bf16 v[176:179], a[192:195], a[228:231], v[176:179]
    v_exp_f32 v82, v82
    v_mfma_f32_16x16x32_bf16 v[180:183], a[196:199], a[228:231], v[180:183]
    v_add_f32 v28, v28, v82
    v_fma_f32 v83, v83, s27, v22
    v_mfma_f32_16x16x32_bf16 v[184:187], a[200:203], a[228:231], v[184:187]
    ds_read_b64_tr_b16 a[212:213], v4 offset:8192
    ds_read_b64_tr_b16 a[214:215], v4 offset:10240
    v_mfma_f32_16x16x32_bf16 v[188:191], a[204:207], a[228:231], v[188:191]
    buffer_load_dwordx4 v13, s[8:11], s22 offen offset:2048 lds
    v_mfma_f32_16x16x32_bf16 v[192:195], a[192:195], a[232:235], v[192:195]
    ds_read_b128 a[248:251], v9 offset:0
    ds_read_b128 a[252:255], v9 offset:1024
    v_mfma_f32_16x16x32_bf16 v[196:199], a[196:199], a[232:235], v[196:199]
    v_exp_f32 v83, v83
    v_mfma_f32_16x16x32_bf16 v[200:203], a[200:203], a[232:235], v[200:203]
    ds_read_b64_tr_b16 a[216:217], v5 offset:8192
    ds_read_b64_tr_b16 a[218:219], v5 offset:10240
    v_mfma_f32_16x16x32_bf16 v[204:207], a[204:207], a[232:235], v[204:207]
    buffer_load_dwordx4 v14, s[8:11], s22 offen offset:3072 lds
    v_mfma_f32_16x16x32_bf16 v[208:211], a[192:195], a[236:239], v[208:211]
    v_cvt_pk_bf16_f32 v49, v82, v83
    v_add_f32 v28, v28, v83
    v_mfma_f32_16x16x32_bf16 v[212:215], a[196:199], a[236:239], v[212:215]
    v_fma_f32 v84, v84, s27, v22
    v_fma_f32 v85, v85, s27, v22
    v_mfma_f32_16x16x32_bf16 v[216:219], a[200:203], a[236:239], v[216:219]
    ds_read_b64_tr_b16 a[220:221], v6 offset:8192
    ds_read_b64_tr_b16 a[222:223], v6 offset:10240
    v_mfma_f32_16x16x32_bf16 v[220:223], a[204:207], a[236:239], v[220:223]
    s_waitcnt lgkmcnt(6)
    v_exp_f32 v84, v84
    v_mfma_f32_16x16x32_bf16 v[224:227], a[192:195], a[240:243], v[224:227]
    s_add_u32 m0, s21, 4096
    ds_read_b128 a[224:227], v9 offset:2048
    ds_read_b128 a[228:231], v9 offset:3072
    v_mfma_f32_16x16x32_bf16 v[228:231], a[196:199], a[240:243], v[228:231]
    s_add_u32 s22, s24, s92
    v_exp_f32 v85, v85
    v_mfma_f32_16x16x32_bf16 v[232:235], a[200:203], a[240:243], v[232:235]
    buffer_load_dwordx4 v15, s[12:15], s22 offen lds
    v_mfma_f32_16x16x32_bf16 v[236:239], a[204:207], a[240:243], v[236:239]
    v_cvt_pk_bf16_f32 v50, v84, v85
    v_add_f32 v28, v28, v84
    v_mfma_f32_16x16x32_bf16 v[240:243], a[192:195], a[244:247], v[240:243]
    v_add_f32 v28, v28, v85
    v_fma_f32 v86, v86, s27, v22
    v_mfma_f32_16x16x32_bf16 v[244:247], a[196:199], a[244:247], v[244:247]
    v_exp_f32 v86, v86
    v_mfma_f32_16x16x32_bf16 v[248:251], a[200:203], a[244:247], v[248:251]
    v_add_f32 v28, v28, v86
    v_fma_f32 v87, v87, s27, v22
    v_mfma_f32_16x16x32_bf16 v[252:255], a[204:207], a[244:247], v[252:255]
    s_waitcnt lgkmcnt(2)
    buffer_load_dwordx4 v16, s[12:15], s22 offen offset:1024 lds
    v_mfma_f32_16x16x32_bf16 v[160:163], a[208:211], a[248:251], v[160:163]
    ds_read_b128 a[232:235], v9 offset:4096
    ds_read_b128 a[236:239], v9 offset:5120
    v_mfma_f32_16x16x32_bf16 v[164:167], a[212:215], a[248:251], v[164:167]
    v_exp_f32 v87, v87
    v_mfma_f32_16x16x32_bf16 v[168:171], a[216:219], a[248:251], v[168:171]
    s_waitcnt vmcnt(22)
    ds_read_b64_tr_b16 a[192:193], v3 offset:12288
    ds_read_b64_tr_b16 a[194:195], v3 offset:14336
    v_mfma_f32_16x16x32_bf16 v[172:175], a[220:223], a[248:251], v[172:175]
    v_cvt_pk_bf16_f32 v51, v86, v87
    v_add_f32 v28, v28, v87
    v_mfma_f32_16x16x32_bf16 v[176:179], a[208:211], a[252:255], v[176:179]
    buffer_load_dwordx4 v17, s[12:15], s22 offen offset:2048 lds
    v_mfma_f32_16x16x32_bf16 v[180:183], a[212:215], a[252:255], v[180:183]
    v_fma_f32 v88, v88, s27, v23
    v_fma_f32 v89, v89, s27, v23
    v_mfma_f32_16x16x32_bf16 v[184:187], a[216:219], a[252:255], v[184:187]
    ds_read_b64_tr_b16 a[196:197], v4 offset:12288
    ds_read_b64_tr_b16 a[198:199], v4 offset:14336
    v_mfma_f32_16x16x32_bf16 v[188:191], a[220:223], a[252:255], v[188:191]
    s_waitcnt lgkmcnt(6)
    v_exp_f32 v88, v88
    v_mfma_f32_16x16x32_bf16 v[192:195], a[208:211], a[224:227], v[192:195]
    ds_read_b128 a[240:243], v10 offset:0
    ds_read_b128 a[244:247], v10 offset:1024
    v_mfma_f32_16x16x32_bf16 v[196:199], a[212:215], a[224:227], v[196:199]
    buffer_load_dwordx4 v18, s[12:15], s22 offen offset:3072 lds
    v_mfma_f32_16x16x32_bf16 v[200:203], a[216:219], a[224:227], v[200:203]
    ds_read_b64_tr_b16 a[200:201], v5 offset:12288
    ds_read_b64_tr_b16 a[202:203], v5 offset:14336
    v_mfma_f32_16x16x32_bf16 v[204:207], a[220:223], a[224:227], v[204:207]
    v_exp_f32 v89, v89
    v_mfma_f32_16x16x32_bf16 v[208:211], a[208:211], a[228:231], v[208:211]
    v_cvt_pk_bf16_f32 v52, v88, v89
    v_add_f32 v29, v29, v88
    v_mfma_f32_16x16x32_bf16 v[212:215], a[212:215], a[228:231], v[212:215]
    s_add_u32 s22, s25, s92
    v_add_f32 v29, v29, v89
    v_fma_f32 v90, v90, s27, v23
    v_mfma_f32_16x16x32_bf16 v[216:219], a[216:219], a[228:231], v[216:219]
    s_add_u32 m0, s21, 8192
    ds_read_b64_tr_b16 a[204:205], v6 offset:12288
    ds_read_b64_tr_b16 a[206:207], v6 offset:14336
    v_mfma_f32_16x16x32_bf16 v[220:223], a[220:223], a[228:231], v[220:223]
    s_waitcnt lgkmcnt(6)
    v_exp_f32 v90, v90
    v_mfma_f32_16x16x32_bf16 v[224:227], a[208:211], a[232:235], v[224:227]
    ds_read_b128 a[248:251], v10 offset:2048
    ds_read_b128 a[252:255], v10 offset:3072
    v_mfma_f32_16x16x32_bf16 v[228:231], a[212:215], a[232:235], v[228:231]
    buffer_load_dwordx4 v15, s[12:15], s22 offen lds
    v_mfma_f32_16x16x32_bf16 v[232:235], a[216:219], a[232:235], v[232:235]
    v_add_f32 v29, v29, v90
    v_fma_f32 v91, v91, s27, v23
    v_mfma_f32_16x16x32_bf16 v[236:239], a[220:223], a[232:235], v[236:239]
    v_exp_f32 v91, v91
    v_mfma_f32_16x16x32_bf16 v[240:243], a[208:211], a[236:239], v[240:243]
    v_cvt_pk_bf16_f32 v53, v90, v91
    v_add_f32 v29, v29, v91
    v_mfma_f32_16x16x32_bf16 v[244:247], a[212:215], a[236:239], v[244:247]
    buffer_load_dwordx4 v16, s[12:15], s22 offen offset:1024 lds
    v_mfma_f32_16x16x32_bf16 v[248:251], a[216:219], a[236:239], v[248:251]
    v_fma_f32 v92, v92, s27, v23
    v_fma_f32 v93, v93, s27, v23
    v_mfma_f32_16x16x32_bf16 v[252:255], a[220:223], a[236:239], v[252:255]
    s_waitcnt lgkmcnt(2)
    v_exp_f32 v92, v92
    v_mfma_f32_16x16x32_bf16 v[160:163], a[192:195], a[240:243], v[160:163]
    ds_read_b128 a[224:227], v10 offset:4096
    ds_read_b128 a[228:231], v10 offset:5120
    v_mfma_f32_16x16x32_bf16 v[164:167], a[196:199], a[240:243], v[164:167]
    v_exp_f32 v93, v93
    v_mfma_f32_16x16x32_bf16 v[168:171], a[200:203], a[240:243], v[168:171]
    buffer_load_dwordx4 v17, s[12:15], s22 offen offset:2048 lds
    v_mfma_f32_16x16x32_bf16 v[172:175], a[204:207], a[240:243], v[172:175]
    v_cvt_pk_bf16_f32 v54, v92, v93
    v_add_f32 v29, v29, v92
    v_mfma_f32_16x16x32_bf16 v[176:179], a[192:195], a[244:247], v[176:179]
    v_add_f32 v29, v29, v93
    v_fma_f32 v94, v94, s27, v23
    v_mfma_f32_16x16x32_bf16 v[180:183], a[196:199], a[244:247], v[180:183]
    v_exp_f32 v94, v94
    v_mfma_f32_16x16x32_bf16 v[184:187], a[200:203], a[244:247], v[184:187]
    v_add_f32 v29, v29, v94
    v_fma_f32 v95, v95, s27, v23
    v_mfma_f32_16x16x32_bf16 v[188:191], a[204:207], a[244:247], v[188:191]
    s_waitcnt lgkmcnt(2)
    buffer_load_dwordx4 v18, s[12:15], s22 offen offset:3072 lds
    v_mfma_f32_16x16x32_bf16 v[192:195], a[192:195], a[248:251], v[192:195]
    s_waitcnt vmcnt(16)
    ds_read_b128 a[208:211], v1 offset:16384
    ds_read_b128 a[212:215], v2 offset:16384
    v_mfma_f32_16x16x32_bf16 v[196:199], a[196:199], a[248:251], v[196:199]
    v_exp_f32 v95, v95
    v_mfma_f32_16x16x32_bf16 v[200:203], a[200:203], a[248:251], v[200:203]
    ds_read_b128 a[216:219], v35 offset:16384
    ds_read_b128 a[220:223], v39 offset:16384
    v_mfma_f32_16x16x32_bf16 v[204:207], a[204:207], a[248:251], v[204:207]
    v_cvt_pk_bf16_f32 v55, v94, v95
    v_add_f32 v29, v29, v95
    v_mfma_f32_16x16x32_bf16 v[208:211], a[192:195], a[252:255], v[208:211]
    s_add_u32 m0, s21, 12288
    ds_read_b128 a[232:235], v1 offset:16640
    ds_read_b128 a[236:239], v2 offset:16640
    v_mfma_f32_16x16x32_bf16 v[212:215], a[196:199], a[252:255], v[212:215]
    s_add_u32 s22, s26, s92
    v_fma_f32 v96, v96, s27, v24
    v_fma_f32 v97, v97, s27, v24
    v_mfma_f32_16x16x32_bf16 v[216:219], a[200:203], a[252:255], v[216:219]
    ds_read_b128 a[240:243], v35 offset:16640
    ds_read_b128 a[244:247], v39 offset:16640
    v_mfma_f32_16x16x32_bf16 v[220:223], a[204:207], a[252:255], v[220:223]
    s_waitcnt lgkmcnt(8)
    buffer_load_dwordx4 v15, s[12:15], s22 offen lds
    v_mfma_f32_16x16x32_bf16 v[224:227], a[192:195], a[224:227], v[224:227]
    v_exp_f32 v96, v96
    v_mfma_f32_16x16x32_bf16 v[228:231], a[196:199], a[224:227], v[228:231]
    v_exp_f32 v97, v97
    v_mfma_f32_16x16x32_bf16 v[232:235], a[200:203], a[224:227], v[232:235]
    v_cvt_pk_bf16_f32 v56, v96, v97
    v_add_f32 v30, v30, v96
    v_mfma_f32_16x16x32_bf16 v[236:239], a[204:207], a[224:227], v[236:239]
    buffer_load_dwordx4 v16, s[12:15], s22 offen offset:1024 lds
    v_mfma_f32_16x16x32_bf16 v[240:243], a[192:195], a[228:231], v[240:243]
    v_add_f32 v30, v30, v97
    v_fma_f32 v98, v98, s27, v24
    v_mfma_f32_16x16x32_bf16 v[244:247], a[196:199], a[228:231], v[244:247]
    v_exp_f32 v98, v98
    v_mfma_f32_16x16x32_bf16 v[248:251], a[200:203], a[228:231], v[248:251]
    v_add_f32 v30, v30, v98
    v_fma_f32 v99, v99, s27, v24
    v_mfma_f32_16x16x32_bf16 v[252:255], a[204:207], a[228:231], v[252:255]
    s_waitcnt lgkmcnt(0)
    v_exp_f32 v99, v99
    v_mfma_f32_16x16x32_bf16 v[112:115], a[208:211], a[0:3], 0
    buffer_load_dwordx4 v17, s[12:15], s22 offen offset:2048 lds
    v_mfma_f32_16x16x32_bf16 v[112:115], a[212:215], a[4:7], v[112:115]
    ds_read_b64_tr_b16 a[192:193], v3 offset:0
    ds_read_b64_tr_b16 a[194:195], v3 offset:2048
    v_mfma_f32_16x16x32_bf16 v[112:115], a[216:219], a[8:11], v[112:115]
    v_cvt_pk_bf16_f32 v57, v98, v99
    v_add_f32 v30, v30, v99
    v_mfma_f32_16x16x32_bf16 v[112:115], a[220:223], a[12:15], v[112:115]
    ds_read_b64_tr_b16 a[196:197], v4 offset:0
    ds_read_b64_tr_b16 a[198:199], v4 offset:2048
    v_mfma_f32_16x16x32_bf16 v[112:115], a[232:235], a[16:19], v[112:115]
    v_fma_f32 v100, v100, s27, v24
    v_fma_f32 v101, v101, s27, v24
    v_mfma_f32_16x16x32_bf16 v[112:115], a[236:239], a[20:23], v[112:115]
    ds_read_b64_tr_b16 a[200:201], v5 offset:0
    ds_read_b64_tr_b16 a[202:203], v5 offset:2048
    v_mfma_f32_16x16x32_bf16 v[112:115], a[240:243], a[24:27], v[112:115]
    buffer_load_dwordx4 v18, s[12:15], s22 offen offset:3072 lds
    v_mfma_f32_16x16x32_bf16 v[112:115], a[244:247], a[28:31], v[112:115]
    ds_read_b64_tr_b16 a[204:205], v6 offset:0
    ds_read_b64_tr_b16 a[206:207], v6 offset:2048
    v_mfma_f32_16x16x32_bf16 v[120:123], a[208:211], a[32:35], 0
    v_exp_f32 v100, v100
    v_mfma_f32_16x16x32_bf16 v[120:123], a[212:215], a[36:39], v[120:123]
    v_exp_f32 v101, v101
    v_mfma_f32_16x16x32_bf16 v[120:123], a[216:219], a[40:43], v[120:123]
    s_add_u32 m0, s21, 16384
    v_cvt_pk_bf16_f32 v58, v100, v101
    v_add_f32 v30, v30, v100
    v_mfma_f32_16x16x32_bf16 v[120:123], a[220:223], a[44:47], v[120:123]
    s_add_u32 s22, s96, s94
    v_add_f32 v30, v30, v101
    v_fma_f32 v102, v102, s27, v24
    v_mfma_f32_16x16x32_bf16 v[120:123], a[232:235], a[48:51], v[120:123]
    buffer_load_dwordx4 v11, s[8:11], s22 offen lds
    v_mfma_f32_16x16x32_bf16 v[120:123], a[236:239], a[52:55], v[120:123]
    v_exp_f32 v102, v102
    v_mfma_f32_16x16x32_bf16 v[120:123], a[240:243], a[56:59], v[120:123]
    v_add_f32 v30, v30, v102
    v_fma_f32 v103, v103, s27, v24
    v_mfma_f32_16x16x32_bf16 v[120:123], a[244:247], a[60:63], v[120:123]
    v_exp_f32 v103, v103
    v_mfma_f32_16x16x32_bf16 v[128:131], a[208:211], a[64:67], 0
    v_cvt_pk_bf16_f32 v59, v102, v103
    v_add_f32 v30, v30, v103
    v_mfma_f32_16x16x32_bf16 v[128:131], a[212:215], a[68:71], v[128:131]
    v_fma_f32 v104, v104, s27, v25
    v_fma_f32 v105, v105, s27, v25
    v_mfma_f32_16x16x32_bf16 v[128:131], a[216:219], a[72:75], v[128:131]
    v_exp_f32 v104, v104
    v_mfma_f32_16x16x32_bf16 v[128:131], a[220:223], a[76:79], v[128:131]
    buffer_load_dwordx4 v12, s[8:11], s22 offen offset:1024 lds
    v_mfma_f32_16x16x32_bf16 v[128:131], a[232:235], a[80:83], v[128:131]
    v_exp_f32 v105, v105
    v_mfma_f32_16x16x32_bf16 v[128:131], a[236:239], a[84:87], v[128:131]
    v_cvt_pk_bf16_f32 v60, v104, v105
    v_add_f32 v31, v31, v104
    v_mfma_f32_16x16x32_bf16 v[128:131], a[240:243], a[88:91], v[128:131]
    v_add_f32 v31, v31, v105
    v_fma_f32 v106, v106, s27, v25
    v_mfma_f32_16x16x32_bf16 v[128:131], a[244:247], a[92:95], v[128:131]
    v_exp_f32 v106, v106
    v_mfma_f32_16x16x32_bf16 v[136:139], a[208:211], a[96:99], 0
    v_add_f32 v31, v31, v106
    v_fma_f32 v107, v107, s27, v25
    v_mfma_f32_16x16x32_bf16 v[136:139], a[212:215], a[100:103], v[136:139]
    v_exp_f32 v107, v107
    v_mfma_f32_16x16x32_bf16 v[136:139], a[216:219], a[104:107], v[136:139]
    s_waitcnt vmcnt(14)
    ds_read_b128 a[248:251], v1 offset:24576
    ds_read_b128 a[252:255], v2 offset:24576
    v_mfma_f32_16x16x32_bf16 v[136:139], a[220:223], a[108:111], v[136:139]
    buffer_load_dwordx4 v13, s[8:11], s22 offen offset:2048 lds
    v_mfma_f32_16x16x32_bf16 v[136:139], a[232:235], a[112:115], v[136:139]
    ds_read_b128 a[224:227], v35 offset:24576
    ds_read_b128 a[228:231], v39 offset:24576
    v_mfma_f32_16x16x32_bf16 v[136:139], a[236:239], a[116:119], v[136:139]
    v_cvt_pk_bf16_f32 v61, v106, v107
    v_add_f32 v31, v31, v107
    v_mfma_f32_16x16x32_bf16 v[136:139], a[240:243], a[120:123], v[136:139]
    v_fma_f32 v108, v108, s27, v25
    v_fma_f32 v109, v109, s27, v25
    v_mfma_f32_16x16x32_bf16 v[136:139], a[244:247], a[124:127], v[136:139]
    v_exp_f32 v108, v108
    v_mfma_f32_16x16x32_bf16 v[144:147], a[208:211], a[128:131], 0
    v_exp_f32 v109, v109
    v_mfma_f32_16x16x32_bf16 v[144:147], a[212:215], a[132:135], v[144:147]
    buffer_load_dwordx4 v14, s[8:11], s22 offen offset:3072 lds
    v_mfma_f32_16x16x32_bf16 v[144:147], a[216:219], a[136:139], v[144:147]
    v_cvt_pk_bf16_f32 v62, v108, v109
    v_add_f32 v31, v31, v108
    v_mfma_f32_16x16x32_bf16 v[144:147], a[220:223], a[140:143], v[144:147]
    v_add_f32 v31, v31, v109
    v_fma_f32 v110, v110, s27, v25
    v_mfma_f32_16x16x32_bf16 v[144:147], a[232:235], a[144:147], v[144:147]
    v_exp_f32 v110, v110
    v_mfma_f32_16x16x32_bf16 v[144:147], a[236:239], a[148:151], v[144:147]
    v_add_f32 v31, v31, v110
    v_fma_f32 v111, v111, s27, v25
    v_mfma_f32_16x16x32_bf16 v[144:147], a[240:243], a[152:155], v[144:147]
    s_add_u32 m0, s21, 0
    v_exp_f32 v111, v111
    v_mfma_f32_16x16x32_bf16 v[144:147], a[244:247], a[156:159], v[144:147]
    s_add_u32 s22, s23, s93
    v_cvt_pk_bf16_f32 v63, v110, v111
    v_add_f32 v31, v31, v111
    v_mfma_f32_16x16x32_bf16 v[152:155], a[208:211], a[160:163], 0
    s_waitcnt lgkmcnt(0)
    buffer_load_dwordx4 v15, s[12:15], s22 offen lds
    v_mfma_f32_16x16x32_bf16 v[152:155], a[212:215], a[164:167], v[152:155]
    ds_read_b128 a[208:211], v1 offset:24832
    ds_read_b128 a[212:215], v2 offset:24832
    v_mfma_f32_16x16x32_bf16 v[152:155], a[216:219], a[168:171], v[152:155]
    v_mfma_f32_16x16x32_bf16 v[152:155], a[220:223], a[172:175], v[152:155]
    ds_read_b128 a[216:219], v35 offset:24832
    ds_read_b128 a[220:223], v39 offset:24832
    v_mfma_f32_16x16x32_bf16 v[152:155], a[232:235], a[176:179], v[152:155]
    s_barrier
    v_mfma_f32_16x16x32_bf16 v[152:155], a[236:239], a[180:183], v[152:155]
    ds_write_b128 v7, v[40:43] offset:0
    v_mfma_f32_16x16x32_bf16 v[152:155], a[240:243], a[184:187], v[152:155]
    v_mfma_f32_16x16x32_bf16 v[152:155], a[244:247], a[188:191], v[152:155]
    buffer_load_dwordx4 v16, s[12:15], s22 offen offset:1024 lds
    v_mfma_f32_16x16x32_bf16 v[116:119], a[248:251], a[0:3], 0
    v_mfma_f32_16x16x32_bf16 v[116:119], a[252:255], a[4:7], v[116:119]
    ds_write_b128 v7, v[44:47] offset:1024
    v_mfma_f32_16x16x32_bf16 v[116:119], a[224:227], a[8:11], v[116:119]
    v_mfma_f32_16x16x32_bf16 v[116:119], a[228:231], a[12:15], v[116:119]
    s_waitcnt lgkmcnt(2)
    v_mfma_f32_16x16x32_bf16 v[116:119], a[208:211], a[16:19], v[116:119]
    v_mfma_f32_16x16x32_bf16 v[116:119], a[212:215], a[20:23], v[116:119]
    ds_write_b128 v7, v[48:51] offset:2048
    v_mfma_f32_16x16x32_bf16 v[116:119], a[216:219], a[24:27], v[116:119]
    buffer_load_dwordx4 v17, s[12:15], s22 offen offset:2048 lds
    v_mfma_f32_16x16x32_bf16 v[116:119], a[220:223], a[28:31], v[116:119]
    v_mfma_f32_16x16x32_bf16 v[124:127], a[248:251], a[32:35], 0
    v_mfma_f32_16x16x32_bf16 v[124:127], a[252:255], a[36:39], v[124:127]
    ds_write_b128 v7, v[52:55] offset:3072
    v_mfma_f32_16x16x32_bf16 v[124:127], a[224:227], a[40:43], v[124:127]
    v_mfma_f32_16x16x32_bf16 v[124:127], a[228:231], a[44:47], v[124:127]
    v_mfma_f32_16x16x32_bf16 v[124:127], a[208:211], a[48:51], v[124:127]
    v_mfma_f32_16x16x32_bf16 v[124:127], a[212:215], a[52:55], v[124:127]
    buffer_load_dwordx4 v18, s[12:15], s22 offen offset:3072 lds
    v_mfma_f32_16x16x32_bf16 v[124:127], a[216:219], a[56:59], v[124:127]
    ds_write_b128 v7, v[56:59] offset:4096
    v_mfma_f32_16x16x32_bf16 v[124:127], a[220:223], a[60:63], v[124:127]
    v_fma_f32 v112, v112, s27, v20
    v_fma_f32 v113, v113, s27, v20
    v_mfma_f32_16x16x32_bf16 v[132:135], a[248:251], a[64:67], 0
    v_exp_f32 v112, v112
    v_mfma_f32_16x16x32_bf16 v[132:135], a[252:255], a[68:71], v[132:135]
    v_exp_f32 v113, v113
    v_mfma_f32_16x16x32_bf16 v[132:135], a[224:227], a[72:75], v[132:135]
    ds_write_b128 v7, v[60:63] offset:5120
    v_mfma_f32_16x16x32_bf16 v[132:135], a[228:231], a[76:79], v[132:135]
    v_add_f32 v26, v26, v112
    v_fma_f32 v114, v114, s27, v20
    v_mfma_f32_16x16x32_bf16 v[132:135], a[208:211], a[80:83], v[132:135]
    v_exp_f32 v114, v114
    v_mfma_f32_16x16x32_bf16 v[132:135], a[212:215], a[84:87], v[132:135]
    v_add_f32 v26, v26, v113
    v_fma_f32 v115, v115, s27, v20
    v_mfma_f32_16x16x32_bf16 v[132:135], a[216:219], a[88:91], v[132:135]
    s_add_u32 m0, s21, 20480
    v_exp_f32 v115, v115
    v_mfma_f32_16x16x32_bf16 v[132:135], a[220:223], a[92:95], v[132:135]
    s_add_u32 s22, s97, s94
    v_add_f32 v26, v26, v114
    v_fma_f32 v116, v116, s27, v20
    v_mfma_f32_16x16x32_bf16 v[140:143], a[248:251], a[96:99], 0
    buffer_load_dwordx4 v11, s[8:11], s22 offen lds
    v_mfma_f32_16x16x32_bf16 v[140:143], a[252:255], a[100:103], v[140:143]
    v_exp_f32 v116, v116
    v_mfma_f32_16x16x32_bf16 v[140:143], a[224:227], a[104:107], v[140:143]
    v_add_f32 v26, v26, v115
L_iw4:
    s_cbranch_execz L_iwdone
    v_fma_f32 v117, v117, s27, v20
    v_mfma_f32_16x16x32_bf16 v[140:143], a[228:231], a[108:111], v[140:143]
    v_exp_f32 v117, v117
    v_mfma_f32_16x16x32_bf16 v[140:143], a[208:211], a[112:115], v[140:143]
    v_add_f32 v26, v26, v116
    v_fma_f32 v118, v118, s27, v20
    v_mfma_f32_16x16x32_bf16 v[140:143], a[212:215], a[116:119], v[140:143]
    buffer_load_dwordx4 v12, s[8:11], s22 offen offset:1024 lds
    v_mfma_f32_16x16x32_bf16 v[140:143], a[216:219], a[120:123], v[140:143]
    v_exp_f32 v118, v118
    v_mfma_f32_16x16x32_bf16 v[140:143], a[220:223], a[124:127], v[140:143]
    v_add_f32 v26, v26, v117
    v_fma_f32 v119, v119, s27, v20
    v_mfma_f32_16x16x32_bf16 v[148:151], a[248:251], a[128:131], 0
    v_exp_f32 v119, v119
    v_mfma_f32_16x16x32_bf16 v[148:151], a[252:255], a[132:135], v[148:151]
    v_add_f32 v26, v26, v118
    v_fma_f32 v120, v120, s27, v21
    v_mfma_f32_16x16x32_bf16 v[148:151], a[224:227], a[136:139], v[148:151]
    buffer_load_dwordx4 v13, s[8:11], s22 offen offset:2048 lds
    v_mfma_f32_16x16x32_bf16 v[148:151], a[228:231], a[140:143], v[148:151]
    v_exp_f32 v120, v120
    v_mfma_f32_16x16x32_bf16 v[148:151], a[208:211], a[144:147], v[148:151]
    v_add_f32 v26, v26, v119
    v_add_f32 v27, v27, v120
    v_mfma_f32_16x16x32_bf16 v[148:151], a[212:215], a[148:151], v[148:151]
    v_fma_f32 v121, v121, s27, v21
    v_fma_f32 v122, v122, s27, v21
    v_mfma_f32_16x16x32_bf16 v[148:151], a[216:219], a[152:155], v[148:151]
    v_exp_f32 v121, v121
    v_mfma_f32_16x16x32_bf16 v[148:151], a[220:223], a[156:159], v[148:151]
    buffer_load_dwordx4 v14, s[8:11], s22 offen offset:3072 lds
    v_mfma_f32_16x16x32_bf16 v[156:159], a[248:251], a[160:163], 0
    v_exp_f32 v122, v122
    v_mfma_f32_16x16x32_bf16 v[156:159], a[252:255], a[164:167], v[156:159]
    v_add_f32 v27, v27, v121
    v_fma_f32 v123, v123, s27, v21
    v_mfma_f32_16x16x32_bf16 v[156:159], a[224:227], a[168:171], v[156:159]
    v_exp_f32 v123, v123
    v_mfma_f32_16x16x32_bf16 v[156:159], a[228:231], a[172:175], v[156:159]
    v_add_f32 v27, v27, v122
    v_fma_f32 v124, v124, s27, v21
    v_mfma_f32_16x16x32_bf16 v[156:159], a[208:211], a[176:179], v[156:159]
    s_add_u32 m0, s21, 24576
    v_exp_f32 v124, v124
    v_mfma_f32_16x16x32_bf16 v[156:159], a[212:215], a[180:183], v[156:159]
    s_add_u32 s22, s98, s94
    v_add_f32 v27, v27, v123
    v_fma_f32 v125, v125, s27, v21
    v_mfma_f32_16x16x32_bf16 v[156:159], a[216:219], a[184:187], v[156:159]
    buffer_load_dwordx4 v11, s[8:11], s22 offen lds
    v_mfma_f32_16x16x32_bf16 v[156:159], a[220:223], a[188:191], v[156:159]
    v_exp_f32 v125, v125
    v_mfma_f32_16x16x32_bf16 v[160:163], a[192:195], v[40:43], v[160:163]
    s_waitcnt vmcnt(21)
    ds_read_b64_tr_b16 a[208:209], v3 offset:4096
    ds_read_b64_tr_b16 a[210:211], v3 offset:6144
    v_mfma_f32_16x16x32_bf16 v[164:167], a[196:199], v[40:43], v[164:167]
    v_add_f32 v27, v27, v124
    v_fma_f32 v126, v126, s27, v21
    v_mfma_f32_16x16x32_bf16 v[168:171], a[200:203], v[40:43], v[168:171]
    v_exp_f32 v126, v126
    v_mfma_f32_16x16x32_bf16 v[172:175], a[204:207], v[40:43], v[172:175]
    ds_read_b64_tr_b16 a[212:213], v4 offset:4096
    ds_read_b64_tr_b16 a[214:215], v4 offset:6144
    v_mfma_f32_16x16x32_bf16 v[176:179], a[192:195], v[44:47], v[176:179]
    buffer_load_dwordx4 v12, s[8:11], s22 offen offset:1024 lds
    v_mfma_f32_16x16x32_bf16 v[180:183], a[196:199], v[44:47], v[180:183]
    v_cvt_pk_bf16_f32 v40, v112, v113
    v_cvt_pk_bf16_f32 v41, v114, v115
    v_mfma_f32_16x16x32_bf16 v[184:187], a[200:203], v[44:47], v[184:187]
    ds_read_b64_tr_b16 a[216:217], v5 offset:4096
    ds_read_b64_tr_b16 a[218:219], v5 offset:6144
    v_mfma_f32_16x16x32_bf16 v[188:191], a[204:207], v[44:47], v[188:191]
    v_cvt_pk_bf16_f32 v42, v116, v117
    v_cvt_pk_bf16_f32 v43, v118, v119
    v_mfma_f32_16x16x32_bf16 v[192:195], a[192:195], v[48:51], v[192:195]
    buffer_load_dwordx4 v13, s[8:11], s22 offen offset:2048 lds
    v_mfma_f32_16x16x32_bf16 v[196:199], a[196:199], v[48:51], v[196:199]
    ds_read_b64_tr_b16 a[220:221], v6 offset:4096
    ds_read_b64_tr_b16 a[222:223], v6 offset:6144
    v_mfma_f32_16x16x32_bf16 v[200:203], a[200:203], v[48:51], v[200:203]
    v_cvt_pk_bf16_f32 v44, v120, v121
    v_cvt_pk_bf16_f32 v45, v122, v123
    v_mfma_f32_16x16x32_bf16 v[204:207], a[204:207], v[48:51], v[204:207]
    v_cvt_pk_bf16_f32 v46, v124, v125
    v_add_f32 v27, v27, v125
    v_mfma_f32_16x16x32_bf16 v[208:211], a[192:195], v[52:55], v[208:211]
    v_add_f32 v27, v27, v126
    v_fma_f32 v127, v127, s27, v21
    v_mfma_f32_16x16x32_bf16 v[212:215], a[196:199], v[52:55], v[212:215]
    buffer_load_dwordx4 v14, s[8:11], s22 offen offset:3072 lds
    v_mfma_f32_16x16x32_bf16 v[216:219], a[200:203], v[52:55], v[216:219]
    v_exp_f32 v127, v127
    v_mfma_f32_16x16x32_bf16 v[220:223], a[204:207], v[52:55], v[220:223]
    s_waitcnt lgkmcnt(2)
    s_barrier
    v_mfma_f32_16x16x32_bf16 v[224:227], a[192:195], v[56:59], v[224:227]
    ds_read_b128 a[224:227], v8 offset:0
    ds_read_b128 a[228:231], v8 offset:1024
    v_mfma_f32_16x16x32_bf16 v[228:231], a[196:199], v[56:59], v[228:231]
    v_cvt_pk_bf16_f32 v47, v126, v127
    v_add_f32 v27, v27, v127
    v_mfma_f32_16x16x32_bf16 v[232:235], a[200:203], v[56:59], v[232:235]
    s_add_u32 m0, s21, 28672
    v_fma_f32 v128, v128, s27, v22
    v_fma_f32 v129, v129, s27, v22
    v_mfma_f32_16x16x32_bf16 v[236:239], a[204:207], v[56:59], v[236:239]
    s_add_u32 s22, s99, s94
    ds_read_b128 a[232:235], v8 offset:2048
    ds_read_b128 a[236:239], v8 offset:3072
    v_mfma_f32_16x16x32_bf16 v[240:243], a[192:195], v[60:63], v[240:243]
    buffer_load_dwordx4 v11, s[8:11], s22 offen lds
    v_mfma_f32_16x16x32_bf16 v[244:247], a[196:199], v[60:63], v[244:247]
    v_exp_f32 v128, v128
    v_mfma_f32_16x16x32_bf16 v[248:251], a[200:203], v[60:63], v[248:251]
    v_exp_f32 v129, v129
    v_mfma_f32_16x16x32_bf16 v[252:255], a[204:207], v[60:63], v[252:255]
    s_waitcnt lgkmcnt(3)
    v_cvt_pk_bf16_f32 v48, v128, v129
    v_add_f32 v28, v28, v128
    v_mfma_f32_16x16x32_bf16 v[160:163], a[208:211], a[224:227], v[160:163]
    ds_read_b128 a[240:243], v8 offset:4096
    ds_read_b128 a[244:247], v8 offset:5120
    v_mfma_f32_16x16x32_bf16 v[164:167], a[212:215], a[224:227], v[164:167]
    buffer_load_dwordx4 v12, s[8:11], s22 offen offset:1024 lds
    v_mfma_f32_16x16x32_bf16 v[168:171], a[216:219], a[224:227], v[168:171]
    s_waitcnt vmcnt(22)
    ds_read_b64_tr_b16 a[192:193], v3 offset:8192
    ds_read_b64_tr_b16 a[194:195], v3 offset:10240
    v_mfma_f32_16x16x32_bf16 v[172:175], a[220:223], a[224:227], v[172:175]
    s_waitcnt lgkmcnt(4)
    v_add_f32 v28, v28, v129
    v_fma_f32 v130, v130, s27, v22
    v_mfma_f32_16x16x32_bf16 v[176:179], a[208:211], a[228:231], v[176:179]
    v_exp_f32 v130, v130
    v_mfma_f32_16x16x32_bf16 v[180:183], a[212:215], a[228:231], v[180:183]
    v_add_f32 v28, v28, v130
    v_fma_f32 v131, v131, s27, v22
    v_mfma_f32_16x16x32_bf16 v[184:187], a[216:219], a[228:231], v[184:187]
    ds_read_b64_tr_b16 a[196:197], v4 offset:8192
    ds_read_b64_tr_b16 a[198:199], v4 offset:10240
    v_mfma_f32_16x16x32_bf16 v[188:191], a[220:223], a[228:231], v[188:191]
    buffer_load_dwordx4 v13, s[8:11], s22 offen offset:2048 lds
    v_mfma_f32_16x16x32_bf16 v[192:195], a[208:211], a[232:235], v[192:195]
    ds_read_b128 a[248:251], v9 offset:0
    ds_read_b128 a[252:255], v9 offset:1024
    v_mfma_f32_16x16x32_bf16 v[196:199], a[212:215], a[232:235], v[196:199]
    v_exp_f32 v131, v131
    v_mfma_f32_16x16x32_bf16 v[200:203], a[216:219], a[232:235], v[200:203]
    ds_read_b64_tr_b16 a[200:201], v5 offset:8192
    ds_read_b64_tr_b16 a[202:203], v5 offset:10240
    v_mfma_f32_16x16x32_bf16 v[204:207], a[220:223], a[232:235], v[204:207]
    buffer_load_dwordx4 v14, s[8:11], s22 offen offset:3072 lds
    v_mfma_f32_16x16x32_bf16 v[208:211], a[208:211], a[236:239], v[208:211]
    v_cvt_pk_bf16_f32 v49, v130, v131
    v_add_f32 v28, v28, v131
    v_mfma_f32_16x16x32_bf16 v[212:215], a[212:215], a[236:239], v[212:215]
    v_fma_f32 v132, v132, s27, v22
    v_fma_f32 v133, v133, s27, v22
    v_mfma_f32_16x16x32_bf16 v[216:219], a[216:219], a[236:239], v[216:219]
    ds_read_b64_tr_b16 a[204:205], v6 offset:8192
    ds_read_b64_tr_b16 a[206:207], v6 offset:10240
    v_mfma_f32_16x16x32_bf16 v[220:223], a[220:223], a[236:239], v[220:223]
    s_waitcnt lgkmcnt(6)
    v_exp_f32 v132, v132
    v_mfma_f32_16x16x32_bf16 v[224:227], a[208:211], a[240:243], v[224:227]
    s_add_u32 m0, s21, 4096
    ds_read_b128 a[224:227], v9 offset:2048
    ds_read_b128 a[228:231], v9 offset:3072
    v_mfma_f32_16x16x32_bf16 v[228:231], a[212:215], a[240:243], v[228:231]
    s_add_u32 s22, s24, s93
    v_exp_f32 v133, v133
    v_mfma_f32_16x16x32_bf16 v[232:235], a[216:219], a[240:243], v[232:235]
    buffer_load_dwordx4 v15, s[12:15], s22 offen lds
    v_mfma_f32_16x16x32_bf16 v[236:239], a[220:223], a[240:243], v[236:239]
    v_cvt_pk_bf16_f32 v50, v132, v133
    v_add_f32 v28, v28, v132
    v_mfma_f32_16x16x32_bf16 v[240:243], a[208:211], a[244:247], v[240:243]
    v_add_f32 v28, v28, v133
    v_fma_f32 v134, v134, s27, v22
    v_mfma_f32_16x16x32_bf16 v[244:247], a[212:215], a[244:247], v[244:247]
    v_exp_f32 v134, v134
    v_mfma_f32_16x16x32_bf16 v[248:251], a[216:219], a[244:247], v[248:251]
    v_add_f32 v28, v28, v134
    v_fma_f32 v135, v135, s27, v22
    v_mfma_f32_16x16x32_bf16 v[252:255], a[220:223], a[244:247], v[252:255]
    s_waitcnt lgkmcnt(2)
    buffer_load_dwordx4 v16, s[12:15], s22 offen offset:1024 lds
    v_mfma_f32_16x16x32_bf16 v[160:163], a[192:195], a[248:251], v[160:163]
    ds_read_b128 a[232:235], v9 offset:4096
    ds_read_b128 a[236:239], v9 offset:5120
    v_mfma_f32_16x16x32_bf16 v[164:167], a[196:199], a[248:251], v[164:167]
    v_exp_f32 v135, v135
    v_mfma_f32_16x16x32_bf16 v[168:171], a[200:203], a[248:251], v[168:171]
    s_waitcnt vmcnt(22)
    ds_read_b64_tr_b16 a[208:209], v3 offset:12288
    ds_read_b64_tr_b16 a[210:211], v3 offset:14336
    v_mfma_f32_16x16x32_bf16 v[172:175], a[204:207], a[248:251], v[172:175]
    v_cvt_pk_bf16_f32 v51, v134, v135
    v_add_f32 v28, v28, v135
    v_mfma_f32_16x16x32_bf16 v[176:179], a[192:195], a[252:255], v[176:179]
    buffer_load_dwordx4 v17, s[12:15], s22 offen offset:2048 lds
    v_mfma_f32_16x16x32_bf16 v[180:183], a[196:199], a[252:255], v[180:183]
    v_fma_f32 v136, v136, s27, v23
    v_fma_f32 v137, v137, s27, v23
    v_mfma_f32_16x16x32_bf16 v[184:187], a[200:203], a[252:255], v[184:187]
    ds_read_b64_tr_b16 a[212:213], v4 offset:12288
    ds_read_b64_tr_b16 a[214:215], v4 offset:14336
    v_mfma_f32_16x16x32_bf16 v[188:191], a[204:207], a[252:255], v[188:191]
    s_waitcnt lgkmcnt(6)
    v_exp_f32 v136, v136
    v_mfma_f32_16x16x32_bf16 v[192:195], a[192:195], a[224:227], v[192:195]
    ds_read_b128 a[240:243], v10 offset:0
    ds_read_b128 a[244:247], v10 offset:1024
    v_mfma_f32_16x16x32_bf16 v[196:199], a[196:199], a[224:227], v[196:199]
    buffer_load_dwordx4 v18, s[12:15], s22 offen offset:3072 lds
    v_mfma_f32_16x16x32_bf16 v[200:203], a[200:203], a[224:227], v[200:203]
    ds_read_b64_tr_b16 a[216:217], v5 offset:12288
    ds_read_b64_tr_b16 a[218:219], v5 offset:14336
    v_mfma_f32_16x16x32_bf16 v[204:207], a[204:207], a[224:227], v[204:207]
    v_exp_f32 v137, v137
    v_mfma_f32_16x16x32_bf16 v[208:211], a[192:195], a[228:231], v[208:211]
    v_cvt_pk_bf16_f32 v52, v136, v137
    v_add_f32 v29, v29, v136
    v_mfma_f32_16x16x32_bf16 v[212:215], a[196:199], a[228:231], v[212:215]
    s_add_u32 s22, s25, s93
    v_add_f32 v29, v29, v137
    v_fma_f32 v138, v138, s27, v23
    v_mfma_f32_16x16x32_bf16 v[216:219], a[200:203], a[228:231], v[216:219]
    s_add_u32 m0, s21, 8192
    ds_read_b64_tr_b16 a[220:221], v6 offset:12288
    ds_read_b64_tr_b16 a[222:223], v6 offset:14336
    v_mfma_f32_16x16x32_bf16 v[220:223], a[204:207], a[228:231], v[220:223]
    s_waitcnt lgkmcnt(6)
    v_exp_f32 v138, v138
    v_mfma_f32_16x16x32_bf16 v[224:227], a[192:195], a[232:235], v[224:227]
    ds_read_b128 a[248:251], v10 offset:2048
    ds_read_b128 a[252:255], v10 offset:3072
    v_mfma_f32_16x16x32_bf16 v[228:231], a[196:199], a[232:235], v[228:231]
    buffer_load_dwordx4 v15, s[12:15], s22 offen lds
    v_mfma_f32_16x16x32_bf16 v[232:235], a[200:203], a[232:235], v[232:235]
    v_add_f32 v29, v29, v138
    v_fma_f32 v139, v139, s27, v23
    v_mfma_f32_16x16x32_bf16 v[236:239], a[204:207], a[232:235], v[236:239]
    v_exp_f32 v139, v139
    v_mfma_f32_16x16x32_bf16 v[240:243], a[192:195], a[236:239], v[240:243]
    v_cvt_pk_bf16_f32 v53, v138, v139
    v_add_f32 v29, v29, v139
    v_mfma_f32_16x16x32_bf16 v[244:247], a[196:199], a[236:239], v[244:247]
    buffer_load_dwordx4 v16, s[12:15], s22 offen offset:1024 lds
    v_mfma_f32_16x16x32_bf16 v[248:251], a[200:203], a[236:239], v[248:251]
    v_fma_f32 v140, v140, s27, v23
    v_fma_f32 v141, v141, s27, v23
    v_mfma_f32_16x16x32_bf16 v[252:255], a[204:207], a[236:239], v[252:255]
    s_waitcnt lgkmcnt(2)
    v_exp_f32 v140, v140
    v_mfma_f32_16x16x32_bf16 v[160:163], a[208:211], a[240:243], v[160:163]
    ds_read_b128 a[224:227], v10 offset:4096
    ds_read_b128 a[228:231], v10 offset:5120
    v_mfma_f32_16x16x32_bf16 v[164:167], a[212:215], a[240:243], v[164:167]
    v_exp_f32 v141, v141
    v_mfma_f32_16x16x32_bf16 v[168:171], a[216:219], a[240:243], v[168:171]
    buffer_load_dwordx4 v17, s[12:15], s22 offen offset:2048 lds
    v_mfma_f32_16x16x32_bf16 v[172:175], a[220:223], a[240:243], v[172:175]
    v_cvt_pk_bf16_f32 v54, v140, v141
    v_add_f32 v29, v29, v140
    v_mfma_f32_16x16x32_bf16 v[176:179], a[208:211], a[244:247], v[176:179]
    v_add_f32 v29, v29, v141
    v_fma_f32 v142, v142, s27, v23
    v_mfma_f32_16x16x32_bf16 v[180:183], a[212:215], a[244:247], v[180:183]
    v_exp_f32 v142, v142
    v_mfma_f32_16x16x32_bf16 v[184:187], a[216:219], a[244:247], v[184:187]
    v_add_f32 v29, v29, v142
    v_fma_f32 v143, v143, s27, v23
    v_mfma_f32_16x16x32_bf16 v[188:191], a[220:223], a[244:247], v[188:191]
    s_waitcnt lgkmcnt(2)
    buffer_load_dwordx4 v18, s[12:15], s22 offen offset:3072 lds
    v_mfma_f32_16x16x32_bf16 v[192:195], a[208:211], a[248:251], v[192:195]
    s_waitcnt vmcnt(16)
    ds_read_b128 a[192:195], v1 offset:16384
    ds_read_b128 a[196:199], v2 offset:16384
    v_mfma_f32_16x16x32_bf16 v[196:199], a[212:215], a[248:251], v[196:199]
    v_exp_f32 v143, v143
    v_mfma_f32_16x16x32_bf16 v[200:203], a[216:219], a[248:251], v[200:203]
    ds_read_b128 a[200:203], v35 offset:16384
    ds_read_b128 a[204:207], v39 offset:16384
    v_mfma_f32_16x16x32_bf16 v[204:207], a[220:223], a[248:251], v[204:207]
    v_cvt_pk_bf16_f32 v55, v142, v143
    v_add_f32 v29, v29, v143
    v_mfma_f32_16x16x32_bf16 v[208:211], a[208:211], a[252:255], v[208:211]
    s_add_u32 m0, s21, 12288
    ds_read_b128 a[232:235], v1 offset:16640
    ds_read_b128 a[236:239], v2 offset:16640
    v_mfma_f32_16x16x32_bf16 v[212:215], a[212:215], a[252:255], v[212:215]
    s_add_u32 s22, s26, s93
    v_fma_f32 v144, v144, s27, v24
    v_fma_f32 v145, v145, s27, v24
    v_mfma_f32_16x16x32_bf16 v[216:219], a[216:219], a[252:255], v[216:219]
    ds_read_b128 a[240:243], v35 offset:16640
    ds_read_b128 a[244:247], v39 offset:16640
    v_mfma_f32_16x16x32_bf16 v[220:223], a[220:223], a[252:255], v[220:223]
    s_waitcnt lgkmcnt(8)
    buffer_load_dwordx4 v15, s[12:15], s22 offen lds
    v_mfma_f32_16x16x32_bf16 v[224:227], a[208:211], a[224:227], v[224:227]
    v_exp_f32 v144, v144
    v_mfma_f32_16x16x32_bf16 v[228:231], a[212:215], a[224:227], v[228:231]
    v_exp_f32 v145, v145
    v_mfma_f32_16x16x32_bf16 v[232:235], a[216:219], a[224:227], v[232:235]
    v_cvt_pk_bf16_f32 v56, v144, v145
    v_add_f32 v30, v30, v144
    v_mfma_f32_16x16x32_bf16 v[236:239], a[220:223], a[224:227], v[236:239]
    buffer_load_dwordx4 v16, s[12:15], s22 offen offset:1024 lds
    v_mfma_f32_16x16x32_bf16 v[240:243], a[208:211], a[228:231], v[240:243]
    v_add_f32 v30, v30, v145
    v_fma_f32 v146, v146, s27, v24
    v_mfma_f32_16x16x32_bf16 v[244:247], a[212:215], a[228:231], v[244:247]
    v_exp_f32 v146, v146
    v_mfma_f32_16x16x32_bf16 v[248:251], a[216:219], a[228:231], v[248:251]
    v_add_f32 v30, v30, v146
    v_fma_f32 v147, v147, s27, v24
    v_mfma_f32_16x16x32_bf16 v[252:255], a[220:223], a[228:231], v[252:255]
    s_waitcnt lgkmcnt(0)
    v_exp_f32 v147, v147
    v_mfma_f32_16x16x32_bf16 v[64:67], a[192:195], a[0:3], 0
    buffer_load_dwordx4 v17, s[12:15], s22 offen offset:2048 lds
    v_mfma_f32_16x16x32_bf16 v[64:67], a[196:199], a[4:7], v[64:67]
    ds_read_b64_tr_b16 a[208:209], v3 offset:0
    ds_read_b64_tr_b16 a[210:211], v3 offset:2048
    v_mfma_f32_16x16x32_bf16 v[64:67], a[200:203], a[8:11], v[64:67]
    v_cvt_pk_bf16_f32 v57, v146, v147
    v_add_f32 v30, v30, v147
    v_mfma_f32_16x16x32_bf16 v[64:67], a[204:207], a[12:15], v[64:67]
    ds_read_b64_tr_b16 a[212:213], v4 offset:0
    ds_read_b64_tr_b16 a[214:215], v4 offset:2048
    v_mfma_f32_16x16x32_bf16 v[64:67], a[232:235], a[16:19], v[64:67]
    v_fma_f32 v148, v148, s27, v24
    v_fma_f32 v149, v149, s27, v24
    v_mfma_f32_16x16x32_bf16 v[64:67], a[236:239], a[20:23], v[64:67]
    ds_read_b64_tr_b16 a[216:217], v5 offset:0
    ds_read_b64_tr_b16 a[218:219], v5 offset:2048
    v_mfma_f32_16x16x32_bf16 v[64:67], a[240:243], a[24:27], v[64:67]
    buffer_load_dwordx4 v18, s[12:15], s22 offen offset:3072 lds
    v_mfma_f32_16x16x32_bf16 v[64:67], a[244:247], a[28:31], v[64:67]
    ds_read_b64_tr_b16 a[220:221], v6 offset:0
    ds_read_b64_tr_b16 a[222:223], v6 offset:2048
    v_mfma_f32_16x16x32_bf16 v[72:75], a[192:195], a[32:35], 0
    v_exp_f32 v148, v148
    v_mfma_f32_16x16x32_bf16 v[72:75], a[196:199], a[36:39], v[72:75]
    v_exp_f32 v149, v149
    v_mfma_f32_16x16x32_bf16 v[72:75], a[200:203], a[40:43], v[72:75]
    s_add_u32 m0, s21, 16384
    v_cvt_pk_bf16_f32 v58, v148, v149
    v_add_f32 v30, v30, v148
    v_mfma_f32_16x16x32_bf16 v[72:75], a[204:207], a[44:47], v[72:75]
    s_add_u32 s22, s96, s95
    v_add_f32 v30, v30, v149
    v_fma_f32 v150, v150, s27, v24
    v_mfma_f32_16x16x32_bf16 v[72:75], a[232:235], a[48:51], v[72:75]
    buffer_load_dwordx4 v11, s[8:11], s22 offen lds
    v_mfma_f32_16x16x32_bf16 v[72:75], a[236:239], a[52:55], v[72:75]
    v_exp_f32 v150, v150
    v_mfma_f32_16x16x32_bf16 v[72:75], a[240:243], a[56:59], v[72:75]
    v_add_f32 v30, v30, v150
    v_fma_f32 v151, v151, s27, v24
    v_mfma_f32_16x16x32_bf16 v[72:75], a[244:247], a[60:63], v[72:75]
    v_exp_f32 v151, v151
    v_mfma_f32_16x16x32_bf16 v[80:83], a[192:195], a[64:67], 0
    v_cvt_pk_bf16_f32 v59, v150, v151
    v_add_f32 v30, v30, v151
    v_mfma_f32_16x16x32_bf16 v[80:83], a[196:199], a[68:71], v[80:83]
    v_fma_f32 v152, v152, s27, v25
    v_fma_f32 v153, v153, s27, v25
    v_mfma_f32_16x16x32_bf16 v[80:83], a[200:203], a[72:75], v[80:83]
    v_exp_f32 v152, v152
    v_mfma_f32_16x16x32_bf16 v[80:83], a[204:207], a[76:79], v[80:83]
    buffer_load_dwordx4 v12, s[8:11], s22 offen offset:1024 lds
    v_mfma_f32_16x16x32_bf16 v[80:83], a[232:235], a[80:83], v[80:83]
    v_exp_f32 v153, v153
    v_mfma_f32_16x16x32_bf16 v[80:83], a[236:239], a[84:87], v[80:83]
    v_cvt_pk_bf16_f32 v60, v152, v153
    v_add_f32 v31, v31, v152
    v_mfma_f32_16x16x32_bf16 v[80:83], a[240:243], a[88:91], v[80:83]
    v_add_f32 v31, v31, v153
    v_fma_f32 v154, v154, s27, v25
    v_mfma_f32_16x16x32_bf16 v[80:83], a[244:247], a[92:95], v[80:83]
    v_exp_f32 v154, v154
    v_mfma_f32_16x16x32_bf16 v[88:91], a[192:195], a[96:99], 0
    v_add_f32 v31, v31, v154
    v_fma_f32 v155, v155, s27, v25
    v_mfma_f32_16x16x32_bf16 v[88:91], a[196:199], a[100:103], v[88:91]
    v_exp_f32 v155, v155
    v_mfma_f32_16x16x32_bf16 v[88:91], a[200:203], a[104:107], v[88:91]
    s_waitcnt vmcnt(14)
    ds_read_b128 a[248:251], v1 offset:24576
    ds_read_b128 a[252:255], v2 offset:24576
    v_mfma_f32_16x16x32_bf16 v[88:91], a[204:207], a[108:111], v[88:91]
    buffer_load_dwordx4 v13, s[8:11], s22 offen offset:2048 lds
    v_mfma_f32_16x16x32_bf16 v[88:91], a[232:235], a[112:115], v[88:91]
    ds_read_b128 a[224:227], v35 offset:24576
    ds_read_b128 a[228:231], v39 offset:24576
    v_mfma_f32_16x16x32_bf16 v[88:91], a[236:239], a[116:119], v[88:91]
    v_cvt_pk_bf16_f32 v61, v154, v155
    v_add_f32 v31, v31, v155
    v_mfma_f32_16x16x32_bf16 v[88:91], a[240:243], a[120:123], v[88:91]
    v_fma_f32 v156, v156, s27, v25
    v_fma_f32 v157, v157, s27, v25
    v_mfma_f32_16x16x32_bf16 v[88:91], a[244:247], a[124:127], v[88:91]
    v_exp_f32 v156, v156
    v_mfma_f32_16x16x32_bf16 v[96:99], a[192:195], a[128:131], 0
    v_exp_f32 v157, v157
    v_mfma_f32_16x16x32_bf16 v[96:99], a[196:199], a[132:135], v[96:99]
    buffer_load_dwordx4 v14, s[8:11], s22 offen offset:3072 lds
    v_mfma_f32_16x16x32_bf16 v[96:99], a[200:203], a[136:139], v[96:99]
    v_cvt_pk_bf16_f32 v62, v156, v157
    v_add_f32 v31, v31, v156
    v_mfma_f32_16x16x32_bf16 v[96:99], a[204:207], a[140:143], v[96:99]
    v_add_f32 v31, v31, v157
    v_fma_f32 v158, v158, s27, v25
    v_mfma_f32_16x16x32_bf16 v[96:99], a[232:235], a[144:147], v[96:99]
    v_exp_f32 v158, v158
    v_mfma_f32_16x16x32_bf16 v[96:99], a[236:239], a[148:151], v[96:99]
    v_add_f32 v31, v31, v158
    v_fma_f32 v159, v159, s27, v25
    v_mfma_f32_16x16x32_bf16 v[96:99], a[240:243], a[152:155], v[96:99]
    s_add_u32 m0, s21, 0
    v_exp_f32 v159, v159
    v_mfma_f32_16x16x32_bf16 v[96:99], a[244:247], a[156:159], v[96:99]
    s_add_u32 s22, s23, s94
    v_cvt_pk_bf16_f32 v63, v158, v159
    v_add_f32 v31, v31, v159
    v_mfma_f32_16x16x32_bf16 v[104:107], a[192:195], a[160:163], 0
    s_waitcnt lgkmcnt(0)
    buffer_load_dwordx4 v15, s[12:15], s22 offen lds
    v_mfma_f32_16x16x32_bf16 v[104:107], a[196:199], a[164:167], v[104:107]
    ds_read_b128 a[192:195], v1 offset:24832
    ds_read_b128 a[196:199], v2 offset:24832
    v_mfma_f32_16x16x32_bf16 v[104:107], a[200:203], a[168:171], v[104:107]
    v_mfma_f32_16x16x32_bf16 v[104:107], a[204:207], a[172:175], v[104:107]
    ds_read_b128 a[200:203], v35 offset:24832
    ds_read_b128 a[204:207], v39 offset:24832
    v_mfma_f32_16x16x32_bf16 v[104:107], a[232:235], a[176:179], v[104:107]
    s_barrier
    v_mfma_f32_16x16x32_bf16 v[104:107], a[236:239], a[180:183], v[104:107]
    ds_write_b128 v7, v[40:43] offset:0
    v_mfma_f32_16x16x32_bf16 v[104:107], a[240:243], a[184:187], v[104:107]
    v_mfma_f32_16x16x32_bf16 v[104:107], a[244:247], a[188:191], v[104:107]
    buffer_load_dwordx4 v16, s[12:15], s22 offen offset:1024 lds
    v_mfma_f32_16x16x32_bf16 v[68:71], a[248:251], a[0:3], 0
    v_mfma_f32_16x16x32_bf16 v[68:71], a[252:255], a[4:7], v[68:71]
    ds_write_b128 v7, v[44:47] offset:1024
    v_mfma_f32_16x16x32_bf16 v[68:71], a[224:227], a[8:11], v[68:71]
    v_mfma_f32_16x16x32_bf16 v[68:71], a[228:231], a[12:15], v[68:71]
    s_waitcnt lgkmcnt(2)
    v_mfma_f32_16x16x32_bf16 v[68:71], a[192:195], a[16:19], v[68:71]
    v_mfma_f32_16x16x32_bf16 v[68:71], a[196:199], a[20:23], v[68:71]
    ds_write_b128 v7, v[48:51] offset:2048
    v_mfma_f32_16x16x32_bf16 v[68:71], a[200:203], a[24:27], v[68:71]
    buffer_load_dwordx4 v17, s[12:15], s22 offen offset:2048 lds
    v_mfma_f32_16x16x32_bf16 v[68:71], a[204:207], a[28:31], v[68:71]
    v_mfma_f32_16x16x32_bf16 v[76:79], a[248:251], a[32:35], 0
    v_mfma_f32_16x16x32_bf16 v[76:79], a[252:255], a[36:39], v[76:79]
    ds_write_b128 v7, v[52:55] offset:3072
    v_mfma_f32_16x16x32_bf16 v[76:79], a[224:227], a[40:43], v[76:79]
    v_mfma_f32_16x16x32_bf16 v[76:79], a[228:231], a[44:47], v[76:79]
    v_mfma_f32_16x16x32_bf16 v[76:79], a[192:195], a[48:51], v[76:79]
    v_mfma_f32_16x16x32_bf16 v[76:79], a[196:199], a[52:55], v[76:79]
    buffer_load_dwordx4 v18, s[12:15], s22 offen offset:3072 lds
    v_mfma_f32_16x16x32_bf16 v[76:79], a[200:203], a[56:59], v[76:79]
    ds_write_b128 v7, v[56:59] offset:4096
    v_mfma_f32_16x16x32_bf16 v[76:79], a[204:207], a[60:63], v[76:79]
    v_fma_f32 v64, v64, s27, v20
    v_fma_f32 v65, v65, s27, v20
    v_mfma_f32_16x16x32_bf16 v[84:87], a[248:251], a[64:67], 0
    v_exp_f32 v64, v64
    v_mfma_f32_16x16x32_bf16 v[84:87], a[252:255], a[68:71], v[84:87]
    v_exp_f32 v65, v65
    v_mfma_f32_16x16x32_bf16 v[84:87], a[224:227], a[72:75], v[84:87]
    ds_write_b128 v7, v[60:63] offset:5120
    v_mfma_f32_16x16x32_bf16 v[84:87], a[228:231], a[76:79], v[84:87]
    v_add_f32 v26, v26, v64
    v_fma_f32 v66, v66, s27, v20
    v_mfma_f32_16x16x32_bf16 v[84:87], a[192:195], a[80:83], v[84:87]
    v_exp_f32 v66, v66
    v_mfma_f32_16x16x32_bf16 v[84:87], a[196:199], a[84:87], v[84:87]
    v_add_f32 v26, v26, v65
    v_fma_f32 v67, v67, s27, v20
    v_mfma_f32_16x16x32_bf16 v[84:87], a[200:203], a[88:91], v[84:87]
    s_add_u32 m0, s21, 20480
    v_exp_f32 v67, v67
    v_mfma_f32_16x16x32_bf16 v[84:87], a[204:207], a[92:95], v[84:87]
    s_add_u32 s22, s97, s95
    v_add_f32 v26, v26, v66
    v_fma_f32 v68, v68, s27, v20
    v_mfma_f32_16x16x32_bf16 v[92:95], a[248:251], a[96:99], 0
    buffer_load_dwordx4 v11, s[8:11], s22 offen lds
    v_mfma_f32_16x16x32_bf16 v[92:95], a[252:255], a[100:103], v[92:95]
    v_exp_f32 v68, v68
    v_mfma_f32_16x16x32_bf16 v[92:95], a[224:227], a[104:107], v[92:95]
    v_add_f32 v26, v26, v67
    v_fma_f32 v69, v69, s27, v20
    v_mfma_f32_16x16x32_bf16 v[92:95], a[228:231], a[108:111], v[92:95]
    v_exp_f32 v69, v69
    v_mfma_f32_16x16x32_bf16 v[92:95], a[192:195], a[112:115], v[92:95]
    v_add_f32 v26, v26, v68
    v_fma_f32 v70, v70, s27, v20
    v_mfma_f32_16x16x32_bf16 v[92:95], a[196:199], a[116:119], v[92:95]
    buffer_load_dwordx4 v12, s[8:11], s22 offen offset:1024 lds
    v_mfma_f32_16x16x32_bf16 v[92:95], a[200:203], a[120:123], v[92:95]
    v_exp_f32 v70, v70
    v_mfma_f32_16x16x32_bf16 v[92:95], a[204:207], a[124:127], v[92:95]
    v_add_f32 v26, v26, v69
    v_fma_f32 v71, v71, s27, v20
    v_mfma_f32_16x16x32_bf16 v[100:103], a[248:251], a[128:131], 0
    v_exp_f32 v71, v71
    v_mfma_f32_16x16x32_bf16 v[100:103], a[252:255], a[132:135], v[100:103]
    v_add_f32 v26, v26, v70
    v_fma_f32 v72, v72, s27, v21
    v_mfma_f32_16x16x32_bf16 v[100:103], a[224:227], a[136:139], v[100:103]
    buffer_load_dwordx4 v13, s[8:11], s22 offen offset:2048 lds
    v_mfma_f32_16x16x32_bf16 v[100:103], a[228:231], a[140:143], v[100:103]
    v_exp_f32 v72, v72
    v_mfma_f32_16x16x32_bf16 v[100:103], a[192:195], a[144:147], v[100:103]
    v_add_f32 v26, v26, v71
    v_add_f32 v27, v27, v72
    v_mfma_f32_16x16x32_bf16 v[100:103], a[196:199], a[148:151], v[100:103]
    v_fma_f32 v73, v73, s27, v21
    v_fma_f32 v74, v74, s27, v21
    v_mfma_f32_16x16x32_bf16 v[100:103], a[200:203], a[152:155], v[100:103]
    v_exp_f32 v73, v73
    v_mfma_f32_16x16x32_bf16 v[100:103], a[204:207], a[156:159], v[100:103]
    buffer_load_dwordx4 v14, s[8:11], s22 offen offset:3072 lds
    v_mfma_f32_16x16x32_bf16 v[108:111], a[248:251], a[160:163], 0
    v_exp_f32 v74, v74
    v_mfma_f32_16x16x32_bf16 v[108:111], a[252:255], a[164:167], v[108:111]
    v_add_f32 v27, v27, v73
    v_fma_f32 v75, v75, s27, v21
    v_mfma_f32_16x16x32_bf16 v[108:111], a[224:227], a[168:171], v[108:111]
    v_exp_f32 v75, v75
    v_mfma_f32_16x16x32_bf16 v[108:111], a[228:231], a[172:175], v[108:111]
    v_add_f32 v27, v27, v74
    v_fma_f32 v76, v76, s27, v21
    v_mfma_f32_16x16x32_bf16 v[108:111], a[192:195], a[176:179], v[108:111]
    s_add_u32 m0, s21, 24576
    v_exp_f32 v76, v76
    v_mfma_f32_16x16x32_bf16 v[108:111], a[196:199], a[180:183], v[108:111]
    s_add_u32 s22, s98, s95
    v_add_f32 v27, v27, v75
    v_fma_f32 v77, v77, s27, v21
    v_mfma_f32_16x16x32_bf16 v[108:111], a[200:203], a[184:187], v[108:111]
    buffer_load_dwordx4 v11, s[8:11], s22 offen lds
    v_mfma_f32_16x16x32_bf16 v[108:111], a[204:207], a[188:191], v[108:111]
    v_exp_f32 v77, v77
    v_mfma_f32_16x16x32_bf16 v[160:163], a[208:211], v[40:43], v[160:163]
    s_waitcnt vmcnt(21)
    ds_read_b64_tr_b16 a[192:193], v3 offset:4096
    ds_read_b64_tr_b16 a[194:195], v3 offset:6144
    v_mfma_f32_16x16x32_bf16 v[164:167], a[212:215], v[40:43], v[164:167]
    v_add_f32 v27, v27, v76
    v_fma_f32 v78, v78, s27, v21
    v_mfma_f32_16x16x32_bf16 v[168:171], a[216:219], v[40:43], v[168:171]
    v_exp_f32 v78, v78
    v_mfma_f32_16x16x32_bf16 v[172:175], a[220:223], v[40:43], v[172:175]
    ds_read_b64_tr_b16 a[196:197], v4 offset:4096
    ds_read_b64_tr_b16 a[198:199], v4 offset:6144
    v_mfma_f32_16x16x32_bf16 v[176:179], a[208:211], v[44:47], v[176:179]
    buffer_load_dwordx4 v12, s[8:11], s22 offen offset:1024 lds
    v_mfma_f32_16x16x32_bf16 v[180:183], a[212:215], v[44:47], v[180:183]
    v_cvt_pk_bf16_f32 v40, v64, v65
    v_cvt_pk_bf16_f32 v41, v66, v67
    v_mfma_f32_16x16x32_bf16 v[184:187], a[216:219], v[44:47], v[184:187]
    ds_read_b64_tr_b16 a[200:201], v5 offset:4096
    ds_read_b64_tr_b16 a[202:203], v5 offset:6144
    v_mfma_f32_16x16x32_bf16 v[188:191], a[220:223], v[44:47], v[188:191]
    v_cvt_pk_bf16_f32 v42, v68, v69
    v_cvt_pk_bf16_f32 v43, v70, v71
    v_mfma_f32_16x16x32_bf16 v[192:195], a[208:211], v[48:51], v[192:195]
    buffer_load_dwordx4 v13, s[8:11], s22 offen offset:2048 lds
    v_mfma_f32_16x16x32_bf16 v[196:199], a[212:215], v[48:51], v[196:199]
    ds_read_b64_tr_b16 a[204:205], v6 offset:4096
    ds_read_b64_tr_b16 a[206:207], v6 offset:6144
    v_mfma_f32_16x16x32_bf16 v[200:203], a[216:219], v[48:51], v[200:203]
    v_cvt_pk_bf16_f32 v44, v72, v73
    v_cvt_pk_bf16_f32 v45, v74, v75
    v_mfma_f32_16x16x32_bf16 v[204:207], a[220:223], v[48:51], v[204:207]
L_iw5:
    s_cbranch_execz L_iwdone
    v_cvt_pk_bf16_f32 v46, v76, v77
    v_add_f32 v27, v27, v77
    v_mfma_f32_16x16x32_bf16 v[208:211], a[208:211], v[52:55], v[208:211]
    v_add_f32 v27, v27, v78
    v_fma_f32 v79, v79, s27, v21
    v_mfma_f32_16x16x32_bf16 v[212:215], a[212:215], v[52:55], v[212:215]
    buffer_load_dwordx4 v14, s[8:11], s22 offen offset:3072 lds
    v_mfma_f32_16x16x32_bf16 v[216:219], a[216:219], v[52:55], v[216:219]
    v_exp_f32 v79, v79
    v_mfma_f32_16x16x32_bf16 v[220:223], a[220:223], v[52:55], v[220:223]
    s_waitcnt lgkmcnt(2)
    s_barrier
    v_mfma_f32_16x16x32_bf16 v[224:227], a[208:211], v[56:59], v[224:227]
    ds_read_b128 a[224:227], v8 offset:0
    ds_read_b128 a[228:231], v8 offset:1024
    v_mfma_f32_16x16x32_bf16 v[228:231], a[212:215], v[56:59], v[228:231]
    v_cvt_pk_bf16_f32 v47, v78, v79
    v_add_f32 v27, v27, v79
    v_mfma_f32_16x16x32_bf16 v[232:235], a[216:219], v[56:59], v[232:235]
    s_add_u32 m0, s21, 28672
    v_fma_f32 v80, v80, s27, v22
    v_fma_f32 v81, v81, s27, v22
    v_mfma_f32_16x16x32_bf16 v[236:239], a[220:223], v[56:59], v[236:239]
    s_add_u32 s22, s99, s95
    ds_read_b128 a[232:235], v8 offset:2048
    ds_read_b128 a[236:239], v8 offset:3072
    v_mfma_f32_16x16x32_bf16 v[240:243], a[208:211], v[60:63], v[240:243]
    buffer_load_dwordx4 v11, s[8:11], s22 offen lds
    v_mfma_f32_16x16x32_bf16 v[244:247], a[212:215], v[60:63], v[244:247]
    v_exp_f32 v80, v80
    v_mfma_f32_16x16x32_bf16 v[248:251], a[216:219], v[60:63], v[248:251]
    v_exp_f32 v81, v81
    v_mfma_f32_16x16x32_bf16 v[252:255], a[220:223], v[60:63], v[252:255]
    s_waitcnt lgkmcnt(3)
    v_cvt_pk_bf16_f32 v48, v80, v81
    v_add_f32 v28, v28, v80
    v_mfma_f32_16x16x32_bf16 v[160:163], a[192:195], a[224:227], v[160:163]
    ds_read_b128 a[240:243], v8 offset:4096
    ds_read_b128 a[244:247], v8 offset:5120
    v_mfma_f32_16x16x32_bf16 v[164:167], a[196:199], a[224:227], v[164:167]
    buffer_load_dwordx4 v12, s[8:11], s22 offen offset:1024 lds
    v_mfma_f32_16x16x32_bf16 v[168:171], a[200:203], a[224:227], v[168:171]
    s_waitcnt vmcnt(22)
    ds_read_b64_tr_b16 a[208:209], v3 offset:8192
    ds_read_b64_tr_b16 a[210:211], v3 offset:10240
    v_mfma_f32_16x16x32_bf16 v[172:175], a[204:207], a[224:227], v[172:175]
    s_waitcnt lgkmcnt(4)
    v_add_f32 v28, v28, v81
    v_fma_f32 v82, v82, s27, v22
    v_mfma_f32_16x16x32_bf16 v[176:179], a[192:195], a[228:231], v[176:179]
    v_exp_f32 v82, v82
    v_mfma_f32_16x16x32_bf16 v[180:183], a[196:199], a[228:231], v[180:183]
    v_add_f32 v28, v28, v82
    v_fma_f32 v83, v83, s27, v22
    v_mfma_f32_16x16x32_bf16 v[184:187], a[200:203], a[228:231], v[184:187]
    ds_read_b64_tr_b16 a[212:213], v4 offset:8192
    ds_read_b64_tr_b16 a[214:215], v4 offset:10240
    v_mfma_f32_16x16x32_bf16 v[188:191], a[204:207], a[228:231], v[188:191]
    buffer_load_dwordx4 v13, s[8:11], s22 offen offset:2048 lds
    v_mfma_f32_16x16x32_bf16 v[192:195], a[192:195], a[232:235], v[192:195]
    ds_read_b128 a[248:251], v9 offset:0
    ds_read_b128 a[252:255], v9 offset:1024
    v_mfma_f32_16x16x32_bf16 v[196:199], a[196:199], a[232:235], v[196:199]
    v_exp_f32 v83, v83
    v_mfma_f32_16x16x32_bf16 v[200:203], a[200:203], a[232:235], v[200:203]
    ds_read_b64_tr_b16 a[216:217], v5 offset:8192
    ds_read_b64_tr_b16 a[218:219], v5 offset:10240
    v_mfma_f32_16x16x32_bf16 v[204:207], a[204:207], a[232:235], v[204:207]
    buffer_load_dwordx4 v14, s[8:11], s22 offen offset:3072 lds
    v_mfma_f32_16x16x32_bf16 v[208:211], a[192:195], a[236:239], v[208:211]
    v_cvt_pk_bf16_f32 v49, v82, v83
    v_add_f32 v28, v28, v83
    v_mfma_f32_16x16x32_bf16 v[212:215], a[196:199], a[236:239], v[212:215]
    v_fma_f32 v84, v84, s27, v22
    v_fma_f32 v85, v85, s27, v22
    v_mfma_f32_16x16x32_bf16 v[216:219], a[200:203], a[236:239], v[216:219]
    ds_read_b64_tr_b16 a[220:221], v6 offset:8192
    ds_read_b64_tr_b16 a[222:223], v6 offset:10240
    v_mfma_f32_16x16x32_bf16 v[220:223], a[204:207], a[236:239], v[220:223]
    s_waitcnt lgkmcnt(6)
    v_exp_f32 v84, v84
    v_mfma_f32_16x16x32_bf16 v[224:227], a[192:195], a[240:243], v[224:227]
    s_add_u32 m0, s21, 4096
    ds_read_b128 a[224:227], v9 offset:2048
    ds_read_b128 a[228:231], v9 offset:3072
    v_mfma_f32_16x16x32_bf16 v[228:231], a[196:199], a[240:243], v[228:231]
    s_add_u32 s22, s24, s94
    v_exp_f32 v85, v85
    v_mfma_f32_16x16x32_bf16 v[232:235], a[200:203], a[240:243], v[232:235]
    buffer_load_dwordx4 v15, s[12:15], s22 offen lds
    v_mfma_f32_16x16x32_bf16 v[236:239], a[204:207], a[240:243], v[236:239]
    v_cvt_pk_bf16_f32 v50, v84, v85
    v_add_f32 v28, v28, v84
    v_mfma_f32_16x16x32_bf16 v[240:243], a[192:195], a[244:247], v[240:243]
    v_add_f32 v28, v28, v85
    v_fma_f32 v86, v86, s27, v22
    v_mfma_f32_16x16x32_bf16 v[244:247], a[196:199], a[244:247], v[244:247]
    v_exp_f32 v86, v86
    v_mfma_f32_16x16x32_bf16 v[248:251], a[200:203], a[244:247], v[248:251]
    v_add_f32 v28, v28, v86
    v_fma_f32 v87, v87, s27, v22
    v_mfma_f32_16x16x32_bf16 v[252:255], a[204:207], a[244:247], v[252:255]
    s_waitcnt lgkmcnt(2)
    buffer_load_dwordx4 v16, s[12:15], s22 offen offset:1024 lds
    v_mfma_f32_16x16x32_bf16 v[160:163], a[208:211], a[248:251], v[160:163]
    ds_read_b128 a[232:235], v9 offset:4096
    ds_read_b128 a[236:239], v9 offset:5120
    v_mfma_f32_16x16x32_bf16 v[164:167], a[212:215], a[248:251], v[164:167]
    v_exp_f32 v87, v87
    v_mfma_f32_16x16x32_bf16 v[168:171], a[216:219], a[248:251], v[168:171]
    s_waitcnt vmcnt(22)
    ds_read_b64_tr_b16 a[192:193], v3 offset:12288
    ds_read_b64_tr_b16 a[194:195], v3 offset:14336
    v_mfma_f32_16x16x32_bf16 v[172:175], a[220:223], a[248:251], v[172:175]
    v_cvt_pk_bf16_f32 v51, v86, v87
    v_add_f32 v28, v28, v87
    v_mfma_f32_16x16x32_bf16 v[176:179], a[208:211], a[252:255], v[176:179]
    buffer_load_dwordx4 v17, s[12:15], s22 offen offset:2048 lds
    v_mfma_f32_16x16x32_bf16 v[180:183], a[212:215], a[252:255], v[180:183]
    v_fma_f32 v88, v88, s27, v23
    v_fma_f32 v89, v89, s27, v23
    v_mfma_f32_16x16x32_bf16 v[184:187], a[216:219], a[252:255], v[184:187]
    ds_read_b64_tr_b16 a[196:197], v4 offset:12288
    ds_read_b64_tr_b16 a[198:199], v4 offset:14336
    v_mfma_f32_16x16x32_bf16 v[188:191], a[220:223], a[252:255], v[188:191]
    s_waitcnt lgkmcnt(6)
    v_exp_f32 v88, v88
    v_mfma_f32_16x16x32_bf16 v[192:195], a[208:211], a[224:227], v[192:195]
    ds_read_b128 a[240:243], v10 offset:0
    ds_read_b128 a[244:247], v10 offset:1024
    v_mfma_f32_16x16x32_bf16 v[196:199], a[212:215], a[224:227], v[196:199]
    buffer_load_dwordx4 v18, s[12:15], s22 offen offset:3072 lds
    v_mfma_f32_16x16x32_bf16 v[200:203], a[216:219], a[224:227], v[200:203]
    ds_read_b64_tr_b16 a[200:201], v5 offset:12288
    ds_read_b64_tr_b16 a[202:203], v5 offset:14336
    v_mfma_f32_16x16x32_bf16 v[204:207], a[220:223], a[224:227], v[204:207]
    v_exp_f32 v89, v89
    v_mfma_f32_16x16x32_bf16 v[208:211], a[208:211], a[228:231], v[208:211]
    v_cvt_pk_bf16_f32 v52, v88, v89
    v_add_f32 v29, v29, v88
    v_mfma_f32_16x16x32_bf16 v[212:215], a[212:215], a[228:231], v[212:215]
    s_add_u32 s22, s25, s94
    v_add_f32 v29, v29, v89
    v_fma_f32 v90, v90, s27, v23
    v_mfma_f32_16x16x32_bf16 v[216:219], a[216:219], a[228:231], v[216:219]
    s_add_u32 m0, s21, 8192
    ds_read_b64_tr_b16 a[204:205], v6 offset:12288
    ds_read_b64_tr_b16 a[206:207], v6 offset:14336
    v_mfma_f32_16x16x32_bf16 v[220:223], a[220:223], a[228:231], v[220:223]
    s_waitcnt lgkmcnt(6)
    v_exp_f32 v90, v90
    v_mfma_f32_16x16x32_bf16 v[224:227], a[208:211], a[232:235], v[224:227]
    ds_read_b128 a[248:251], v10 offset:2048
    ds_read_b128 a[252:255], v10 offset:3072
    v_mfma_f32_16x16x32_bf16 v[228:231], a[212:215], a[232:235], v[228:231]
    buffer_load_dwordx4 v15, s[12:15], s22 offen lds
    v_mfma_f32_16x16x32_bf16 v[232:235], a[216:219], a[232:235], v[232:235]
    v_add_f32 v29, v29, v90
    v_fma_f32 v91, v91, s27, v23
    v_mfma_f32_16x16x32_bf16 v[236:239], a[220:223], a[232:235], v[236:239]
    v_exp_f32 v91, v91
    v_mfma_f32_16x16x32_bf16 v[240:243], a[208:211], a[236:239], v[240:243]
    v_cvt_pk_bf16_f32 v53, v90, v91
    v_add_f32 v29, v29, v91
    v_mfma_f32_16x16x32_bf16 v[244:247], a[212:215], a[236:239], v[244:247]
    buffer_load_dwordx4 v16, s[12:15], s22 offen offset:1024 lds
    v_mfma_f32_16x16x32_bf16 v[248:251], a[216:219], a[236:239], v[248:251]
    v_fma_f32 v92, v92, s27, v23
    v_fma_f32 v93, v93, s27, v23
    v_mfma_f32_16x16x32_bf16 v[252:255], a[220:223], a[236:239], v[252:255]
    s_waitcnt lgkmcnt(2)
    v_exp_f32 v92, v92
    v_mfma_f32_16x16x32_bf16 v[160:163], a[192:195], a[240:243], v[160:163]
    ds_read_b128 a[224:227], v10 offset:4096
    ds_read_b128 a[228:231], v10 offset:5120
    v_mfma_f32_16x16x32_bf16 v[164:167], a[196:199], a[240:243], v[164:167]
    s_waitcnt vmcnt(14)
    ds_read_b128 a[208:211], v1 offset:16384
    ds_read_b128 a[212:215], v2 offset:16384
    v_mfma_f32_16x16x32_bf16 v[168:171], a[200:203], a[240:243], v[168:171]
    buffer_load_dwordx4 v17, s[12:15], s22 offen offset:2048 lds
    v_mfma_f32_16x16x32_bf16 v[172:175], a[204:207], a[240:243], v[172:175]
    v_exp_f32 v93, v93
    v_mfma_f32_16x16x32_bf16 v[176:179], a[192:195], a[244:247], v[176:179]
    ds_read_b128 a[216:219], v35 offset:16384
    ds_read_b128 a[220:223], v39 offset:16384
    v_mfma_f32_16x16x32_bf16 v[180:183], a[196:199], a[244:247], v[180:183]
    v_cvt_pk_bf16_f32 v54, v92, v93
    v_add_f32 v29, v29, v92
    v_mfma_f32_16x16x32_bf16 v[184:187], a[200:203], a[244:247], v[184:187]
    v_add_f32 v29, v29, v93
    v_fma_f32 v94, v94, s27, v23
    v_mfma_f32_16x16x32_bf16 v[188:191], a[204:207], a[244:247], v[188:191]
    s_waitcnt lgkmcnt(6)
    ds_read_b128 a[232:235], v1 offset:16640
    ds_read_b128 a[236:239], v2 offset:16640
    v_mfma_f32_16x16x32_bf16 v[192:195], a[192:195], a[248:251], v[192:195]
    buffer_load_dwordx4 v18, s[12:15], s22 offen offset:3072 lds
    v_mfma_f32_16x16x32_bf16 v[196:199], a[196:199], a[248:251], v[196:199]
    v_exp_f32 v94, v94
    v_mfma_f32_16x16x32_bf16 v[200:203], a[200:203], a[248:251], v[200:203]
    ds_read_b128 a[240:243], v35 offset:16640
    v_add_f32 v29, v29, v94
    v_mfma_f32_16x16x32_bf16 v[204:207], a[204:207], a[248:251], v[204:207]
    v_fma_f32 v95, v95, s27, v23
    v_fma_f32 v96, v96, s27, v24
    v_mfma_f32_16x16x32_bf16 v[208:211], a[192:195], a[252:255], v[208:211]
    s_add_u32 m0, s21, 12288
    v_exp_f32 v95, v95
    v_mfma_f32_16x16x32_bf16 v[212:215], a[196:199], a[252:255], v[212:215]
    s_add_u32 s22, s26, s94
    ds_read_b128 a[244:247], v39 offset:16640
    v_cvt_pk_bf16_f32 v55, v94, v95
    v_mfma_f32_16x16x32_bf16 v[216:219], a[200:203], a[252:255], v[216:219]
    buffer_load_dwordx4 v15, s[12:15], s22 offen lds
    v_mfma_f32_16x16x32_bf16 v[220:223], a[204:207], a[252:255], v[220:223]
    s_waitcnt lgkmcnt(2)
    v_exp_f32 v96, v96
    v_mfma_f32_16x16x32_bf16 v[224:227], a[192:195], a[224:227], v[224:227]
    s_waitcnt vmcnt(9)
    ds_read_b128 a[248:251], v1 offset:24576
    v_add_f32 v29, v29, v95
    v_mfma_f32_16x16x32_bf16 v[228:231], a[196:199], a[224:227], v[228:231]
    v_add_f32 v30, v30, v96
    v_fma_f32 v97, v97, s27, v24
    v_mfma_f32_16x16x32_bf16 v[232:235], a[200:203], a[224:227], v[232:235]
    v_exp_f32 v97, v97
    v_mfma_f32_16x16x32_bf16 v[236:239], a[204:207], a[224:227], v[236:239]
    buffer_load_dwordx4 v16, s[12:15], s22 offen offset:1024 lds
    v_mfma_f32_16x16x32_bf16 v[240:243], a[192:195], a[228:231], v[240:243]
    ds_read_b128 a[252:255], v2 offset:24576
    ds_read_b128 a[224:227], v35 offset:24576
    v_mfma_f32_16x16x32_bf16 v[244:247], a[196:199], a[228:231], v[244:247]
    v_cvt_pk_bf16_f32 v56, v96, v97
    v_add_f32 v30, v30, v97
    v_mfma_f32_16x16x32_bf16 v[248:251], a[200:203], a[228:231], v[248:251]
    v_fma_f32 v98, v98, s27, v24
    v_fma_f32 v99, v99, s27, v24
    v_mfma_f32_16x16x32_bf16 v[252:255], a[204:207], a[228:231], v[252:255]
    v_exp_f32 v98, v98
    v_mfma_f32_16x16x32_bf16 v[112:115], a[208:211], a[0:3], 0
    ds_read_b128 a[228:231], v39 offset:24576
    ds_read_b128 a[192:195], v1 offset:24832
    v_mfma_f32_16x16x32_bf16 v[112:115], a[212:215], a[4:7], v[112:115]
    ds_read_b128 a[196:199], v2 offset:24832
    ds_read_b128 a[200:203], v35 offset:24832
    v_mfma_f32_16x16x32_bf16 v[112:115], a[216:219], a[8:11], v[112:115]
    ds_read_b128 a[204:207], v39 offset:24832
    v_add_f32 v30, v30, v98
    v_mfma_f32_16x16x32_bf16 v[112:115], a[220:223], a[12:15], v[112:115]
    buffer_load_dwordx4 v17, s[12:15], s22 offen offset:2048 lds
    v_mfma_f32_16x16x32_bf16 v[112:115], a[232:235], a[16:19], v[112:115]
    v_exp_f32 v99, v99
    v_mfma_f32_16x16x32_bf16 v[112:115], a[236:239], a[20:23], v[112:115]
    s_waitcnt lgkmcnt(5)
    buffer_load_dwordx4 v18, s[12:15], s22 offen offset:3072 lds
    v_mfma_f32_16x16x32_bf16 v[112:115], a[240:243], a[24:27], v[112:115]
    s_add_u32 m0, s21, 16384
    ds_read_b64_tr_b16 v[64:65], v3 offset:0
    ds_read_b64_tr_b16 v[66:67], v3 offset:2048
    v_mfma_f32_16x16x32_bf16 v[112:115], a[244:247], a[28:31], v[112:115]
    s_add_u32 s22, s23, s95
    v_cvt_pk_bf16_f32 v57, v98, v99
    v_add_f32 v30, v30, v99
    v_mfma_f32_16x16x32_bf16 v[116:119], a[248:251], a[0:3], 0
    ds_read_b64_tr_b16 v[68:69], v4 offset:0
    ds_read_b64_tr_b16 v[70:71], v4 offset:2048
    v_mfma_f32_16x16x32_bf16 v[116:119], a[252:255], a[4:7], v[116:119]
    buffer_load_dwordx4 v15, s[12:15], s22 offen lds
    v_mfma_f32_16x16x32_bf16 v[116:119], a[224:227], a[8:11], v[116:119]
    s_waitcnt lgkmcnt(4)
    ds_read_b64_tr_b16 v[72:73], v5 offset:0
    ds_read_b64_tr_b16 v[74:75], v5 offset:2048
    v_mfma_f32_16x16x32_bf16 v[116:119], a[228:231], a[12:15], v[116:119]
    buffer_load_dwordx4 v16, s[12:15], s22 offen offset:1024 lds
    v_mfma_f32_16x16x32_bf16 v[116:119], a[192:195], a[16:19], v[116:119]
    ds_read_b64_tr_b16 v[76:77], v6 offset:0
    ds_read_b64_tr_b16 v[78:79], v6 offset:2048
    v_mfma_f32_16x16x32_bf16 v[116:119], a[196:199], a[20:23], v[116:119]
    buffer_load_dwordx4 v17, s[12:15], s22 offen offset:2048 lds
    v_mfma_f32_16x16x32_bf16 v[116:119], a[200:203], a[24:27], v[116:119]
    s_waitcnt vmcnt(11)
    ds_read_b64_tr_b16 v[80:81], v3 offset:4096
    ds_read_b64_tr_b16 v[82:83], v3 offset:6144
    v_mfma_f32_16x16x32_bf16 v[116:119], a[204:207], a[28:31], v[116:119]
    buffer_load_dwordx4 v18, s[12:15], s22 offen offset:3072 lds
    v_mfma_f32_16x16x32_bf16 v[120:123], a[208:211], a[32:35], 0
    ds_read_b64_tr_b16 v[84:85], v4 offset:4096
    ds_read_b64_tr_b16 v[86:87], v4 offset:6144
    v_mfma_f32_16x16x32_bf16 v[120:123], a[212:215], a[36:39], v[120:123]
    v_fma_f32 v100, v100, s27, v24
    v_fma_f32 v101, v101, s27, v24
    v_mfma_f32_16x16x32_bf16 v[120:123], a[216:219], a[40:43], v[120:123]
    ds_read_b64_tr_b16 v[88:89], v5 offset:4096
    ds_read_b64_tr_b16 v[90:91], v5 offset:6144
    v_mfma_f32_16x16x32_bf16 v[120:123], a[220:223], a[44:47], v[120:123]
    v_exp_f32 v100, v100
    v_mfma_f32_16x16x32_bf16 v[120:123], a[232:235], a[48:51], v[120:123]
    ds_read_b64_tr_b16 v[92:93], v6 offset:4096
    ds_read_b64_tr_b16 v[94:95], v6 offset:6144
    v_mfma_f32_16x16x32_bf16 v[120:123], a[236:239], a[52:55], v[120:123]
    v_exp_f32 v101, v101
    v_mfma_f32_16x16x32_bf16 v[120:123], a[240:243], a[56:59], v[120:123]
    v_cvt_pk_bf16_f32 v58, v100, v101
    v_add_f32 v30, v30, v100
    v_mfma_f32_16x16x32_bf16 v[120:123], a[244:247], a[60:63], v[120:123]
    s_barrier
    v_mfma_f32_16x16x32_bf16 v[124:127], a[248:251], a[32:35], 0
    ds_write_b128 v7, v[40:43] offset:0
    v_mfma_f32_16x16x32_bf16 v[124:127], a[252:255], a[36:39], v[124:127]
    v_add_f32 v30, v30, v101
    v_fma_f32 v102, v102, s27, v24
    v_mfma_f32_16x16x32_bf16 v[124:127], a[224:227], a[40:43], v[124:127]
    v_exp_f32 v102, v102
    v_mfma_f32_16x16x32_bf16 v[124:127], a[228:231], a[44:47], v[124:127]
    v_add_f32 v30, v30, v102
    v_fma_f32 v103, v103, s27, v24
    v_mfma_f32_16x16x32_bf16 v[124:127], a[192:195], a[48:51], v[124:127]
    ds_write_b128 v7, v[44:47] offset:1024
    v_mfma_f32_16x16x32_bf16 v[124:127], a[196:199], a[52:55], v[124:127]
    v_exp_f32 v103, v103
    v_mfma_f32_16x16x32_bf16 v[124:127], a[200:203], a[56:59], v[124:127]
    v_cvt_pk_bf16_f32 v59, v102, v103
    v_add_f32 v30, v30, v103
    v_mfma_f32_16x16x32_bf16 v[124:127], a[204:207], a[60:63], v[124:127]
    v_fma_f32 v104, v104, s27, v25
    v_fma_f32 v105, v105, s27, v25
    v_mfma_f32_16x16x32_bf16 v[128:131], a[208:211], a[64:67], 0
    ds_write_b128 v7, v[48:51] offset:2048
    v_mfma_f32_16x16x32_bf16 v[128:131], a[212:215], a[68:71], v[128:131]
    v_exp_f32 v104, v104
    v_mfma_f32_16x16x32_bf16 v[128:131], a[216:219], a[72:75], v[128:131]
    v_exp_f32 v105, v105
    v_mfma_f32_16x16x32_bf16 v[128:131], a[220:223], a[76:79], v[128:131]
    v_cvt_pk_bf16_f32 v60, v104, v105
    v_add_f32 v31, v31, v104
    v_mfma_f32_16x16x32_bf16 v[128:131], a[232:235], a[80:83], v[128:131]
    ds_write_b128 v7, v[52:55] offset:3072
    v_mfma_f32_16x16x32_bf16 v[128:131], a[236:239], a[84:87], v[128:131]
    v_add_f32 v31, v31, v105
    v_fma_f32 v106, v106, s27, v25
    v_mfma_f32_16x16x32_bf16 v[128:131], a[240:243], a[88:91], v[128:131]
    s_add_u32 m0, s21, 20480
    v_exp_f32 v106, v106
    v_mfma_f32_16x16x32_bf16 v[128:131], a[244:247], a[92:95], v[128:131]
    s_add_u32 s22, s24, s95
    v_add_f32 v31, v31, v106
    v_fma_f32 v107, v107, s27, v25
    v_mfma_f32_16x16x32_bf16 v[132:135], a[248:251], a[64:67], 0
    buffer_load_dwordx4 v15, s[12:15], s22 offen lds
    v_mfma_f32_16x16x32_bf16 v[132:135], a[252:255], a[68:71], v[132:135]
    ds_write_b128 v7, v[56:59] offset:4096
    v_mfma_f32_16x16x32_bf16 v[132:135], a[224:227], a[72:75], v[132:135]
    v_exp_f32 v107, v107
    v_mfma_f32_16x16x32_bf16 v[132:135], a[228:231], a[76:79], v[132:135]
    v_cvt_pk_bf16_f32 v61, v106, v107
    v_add_f32 v31, v31, v107
    v_mfma_f32_16x16x32_bf16 v[132:135], a[192:195], a[80:83], v[132:135]
    buffer_load_dwordx4 v16, s[12:15], s22 offen offset:1024 lds
    v_mfma_f32_16x16x32_bf16 v[132:135], a[196:199], a[84:87], v[132:135]
    v_fma_f32 v108, v108, s27, v25
    v_fma_f32 v109, v109, s27, v25
    v_mfma_f32_16x16x32_bf16 v[132:135], a[200:203], a[88:91], v[132:135]
    s_lshl_b32 s32, s24, 1
    v_exp_f32 v108, v108
    v_lshl_add_u32 v11, v36, 4, s21
    v_mfma_f32_16x16x32_bf16 v[132:135], a[204:207], a[92:95], v[132:135]
    v_exp_f32 v109, v109
    v_lshl_add_u32 v12, v36, 4, s32
    s_lshl_b32 s32, s25, 1
    v_mfma_f32_16x16x32_bf16 v[136:139], a[208:211], a[96:99], 0
    buffer_load_dwordx4 v17, s[12:15], s22 offen offset:2048 lds
    v_lshl_add_u32 v13, v36, 4, s32
    s_lshl_b32 s32, s26, 1
    v_mfma_f32_16x16x32_bf16 v[136:139], a[212:215], a[100:103], v[136:139]
    v_cvt_pk_bf16_f32 v62, v108, v109
    v_add_f32 v31, v31, v108
    v_lshl_add_u32 v14, v36, 4, s32
    v_mfma_f32_16x16x32_bf16 v[136:139], a[216:219], a[104:107], v[136:139]
    v_add_f32 v31, v31, v109
    v_fma_f32 v110, v110, s27, v25
    v_and_b32 v19, 15, v36
    v_mfma_f32_16x16x32_bf16 v[136:139], a[220:223], a[108:111], v[136:139]
    v_exp_f32 v110, v110
    v_and_b32 v32, 7, v36
    v_mfma_f32_16x16x32_bf16 v[136:139], a[232:235], a[112:115], v[136:139]
    buffer_load_dwordx4 v18, s[12:15], s22 offen offset:3072 lds
    v_lshrrev_b32 v1, 5, v36
    v_mfma_f32_16x16x32_bf16 v[136:139], a[236:239], a[116:119], v[136:139]
    v_add_f32 v31, v31, v110
    v_fma_f32 v111, v111, s27, v25
    v_xor_b32 v32, v1, v32
    v_mfma_f32_16x16x32_bf16 v[136:139], a[240:243], a[120:123], v[136:139]
    v_exp_f32 v111, v111
    v_lshlrev_b32 v32, 4, v32
    v_mfma_f32_16x16x32_bf16 v[136:139], a[244:247], a[124:127], v[136:139]
    v_cvt_pk_bf16_f32 v63, v110, v111
    v_add_f32 v31, v31, v111
    v_lshl_add_u32 v19, v19, 7, v32
    v_mfma_f32_16x16x32_bf16 v[140:143], a[248:251], a[96:99], 0
    ds_write_b128 v7, v[60:63] offset:5120
    v_bfe_u32 v32, v36, 4, 1
    v_mfma_f32_16x16x32_bf16 v[140:143], a[252:255], a[100:103], v[140:143]
    v_lshl_add_u32 v19, v32, 3, v19
    v_add_u32 v1, s21, v19
    v_xor_b32 v2, 32, v1
    v_mfma_f32_16x16x32_bf16 v[140:143], a[224:227], a[104:107], v[140:143]
    s_add_u32 m0, s21, 24576
    v_xor_b32 v35, 64, v1
    v_xor_b32 v39, 96, v1
    v_lshrrev_b32 v19, 3, v36
    v_mfma_f32_16x16x32_bf16 v[140:143], a[228:231], a[108:111], v[140:143]
    s_add_u32 s22, s25, s95
    v_and_b32 v37, 7, v36
    v_xor_b32 v37, v37, v19
    v_lshl_add_u32 v37, v37, 4, s37
    v_mfma_f32_16x16x32_bf16 v[140:143], a[192:195], a[112:115], v[140:143]
    s_waitcnt vmcnt(12)
    ds_read_b64_tr_b16 a[0:1], v3 offset:8192
    ds_read_b64_tr_b16 a[2:3], v3 offset:10240
    v_lshl_add_u32 v37, v19, 9, v37
    v_mfma_f32_16x16x32_bf16 v[140:143], a[196:199], a[116:119], v[140:143]
    buffer_load_dwordx4 v15, s[12:15], s22 offen lds
    v_fma_f32 v112, v112, s27, v20
    v_mfma_f32_16x16x32_bf16 v[140:143], a[200:203], a[120:123], v[140:143]
    v_exp_f32 v112, v112
    v_fma_f32 v113, v113, s27, v20
    v_mfma_f32_16x16x32_bf16 v[140:143], a[204:207], a[124:127], v[140:143]
    ds_read_b64_tr_b16 a[4:5], v4 offset:8192
    ds_read_b64_tr_b16 a[6:7], v4 offset:10240
    v_add_f32 v26, v26, v112
    v_mfma_f32_16x16x32_bf16 v[144:147], a[208:211], a[128:131], 0
    buffer_load_dwordx4 v16, s[12:15], s22 offen offset:1024 lds
    v_fma_f32 v114, v114, s27, v20
    v_mfma_f32_16x16x32_bf16 v[144:147], a[212:215], a[132:135], v[144:147]
    v_exp_f32 v113, v113
    v_fma_f32 v115, v115, s27, v20
    v_mfma_f32_16x16x32_bf16 v[144:147], a[216:219], a[136:139], v[144:147]
    ds_read_b64_tr_b16 a[8:9], v5 offset:8192
    ds_read_b64_tr_b16 a[10:11], v5 offset:10240
    v_add_f32 v26, v26, v113
    v_mfma_f32_16x16x32_bf16 v[144:147], a[220:223], a[140:143], v[144:147]
    v_exp_f32 v114, v114
    v_fma_f32 v116, v116, s27, v20
    v_mfma_f32_16x16x32_bf16 v[144:147], a[232:235], a[144:147], v[144:147]
    buffer_load_dwordx4 v17, s[12:15], s22 offen offset:2048 lds
    v_add_f32 v26, v26, v114
    v_mfma_f32_16x16x32_bf16 v[144:147], a[236:239], a[148:151], v[144:147]
    ds_read_b64_tr_b16 a[12:13], v6 offset:8192
    ds_read_b64_tr_b16 a[14:15], v6 offset:10240
    v_fma_f32 v117, v117, s27, v20
    v_mfma_f32_16x16x32_bf16 v[144:147], a[240:243], a[152:155], v[144:147]
    v_exp_f32 v115, v115
    v_fma_f32 v118, v118, s27, v20
    v_mfma_f32_16x16x32_bf16 v[144:147], a[244:247], a[156:159], v[144:147]
    v_exp_f32 v116, v116
    v_add_f32 v26, v26, v115
    v_mfma_f32_16x16x32_bf16 v[148:151], a[248:251], a[128:131], 0
    s_waitcnt vmcnt(11)
    ds_read_b64_tr_b16 a[16:17], v3 offset:12288
    ds_read_b64_tr_b16 a[18:19], v3 offset:14336
    v_add_f32 v26, v26, v116
    v_mfma_f32_16x16x32_bf16 v[148:151], a[252:255], a[132:135], v[148:151]
    buffer_load_dwordx4 v18, s[12:15], s22 offen offset:3072 lds
    v_fma_f32 v119, v119, s27, v20
    v_mfma_f32_16x16x32_bf16 v[148:151], a[224:227], a[136:139], v[148:151]
    v_exp_f32 v117, v117
    v_fma_f32 v120, v120, s27, v21
    v_mfma_f32_16x16x32_bf16 v[148:151], a[228:231], a[140:143], v[148:151]
    ds_read_b64_tr_b16 a[20:21], v4 offset:12288
    ds_read_b64_tr_b16 a[22:23], v4 offset:14336
    v_add_f32 v26, v26, v117
    v_mfma_f32_16x16x32_bf16 v[148:151], a[192:195], a[144:147], v[148:151]
    v_exp_f32 v118, v118
    v_fma_f32 v121, v121, s27, v21
    v_mfma_f32_16x16x32_bf16 v[148:151], a[196:199], a[148:151], v[148:151]
    v_exp_f32 v119, v119
    v_add_f32 v26, v26, v118
    v_mfma_f32_16x16x32_bf16 v[148:151], a[200:203], a[152:155], v[148:151]
    s_add_u32 m0, s21, 28672
    ds_read_b64_tr_b16 a[24:25], v5 offset:12288
    ds_read_b64_tr_b16 a[26:27], v5 offset:14336
    v_add_f32 v26, v26, v119
    v_mfma_f32_16x16x32_bf16 v[148:151], a[204:207], a[156:159], v[148:151]
    s_add_u32 s22, s26, s95
    v_exp_f32 v120, v120
    v_fma_f32 v122, v122, s27, v21
    v_mfma_f32_16x16x32_bf16 v[152:155], a[208:211], a[160:163], 0
    buffer_load_dwordx4 v15, s[12:15], s22 offen lds
    v_add_f32 v27, v27, v120
    v_mfma_f32_16x16x32_bf16 v[152:155], a[212:215], a[164:167], v[152:155]
    ds_read_b64_tr_b16 a[28:29], v6 offset:12288
    ds_read_b64_tr_b16 a[30:31], v6 offset:14336
    v_fma_f32 v123, v123, s27, v21
    v_mfma_f32_16x16x32_bf16 v[152:155], a[216:219], a[168:171], v[152:155]
    v_exp_f32 v121, v121
    v_fma_f32 v124, v124, s27, v21
    v_mfma_f32_16x16x32_bf16 v[152:155], a[220:223], a[172:175], v[152:155]
    v_exp_f32 v122, v122
    v_add_f32 v27, v27, v121
    v_mfma_f32_16x16x32_bf16 v[152:155], a[232:235], a[176:179], v[152:155]
    buffer_load_dwordx4 v16, s[12:15], s22 offen offset:1024 lds
    v_add_f32 v27, v27, v122
    v_mfma_f32_16x16x32_bf16 v[152:155], a[236:239], a[180:183], v[152:155]
    v_exp_f32 v123, v123
    v_fma_f32 v125, v125, s27, v21
    v_mfma_f32_16x16x32_bf16 v[152:155], a[240:243], a[184:187], v[152:155]
    v_exp_f32 v124, v124
    v_add_f32 v27, v27, v123
    v_mfma_f32_16x16x32_bf16 v[152:155], a[244:247], a[188:191], v[152:155]
    v_exp_f32 v125, v125
    v_add_f32 v27, v27, v124
    v_mfma_f32_16x16x32_bf16 v[156:159], a[248:251], a[160:163], 0
    buffer_load_dwordx4 v17, s[12:15], s22 offen offset:2048 lds
    v_add_f32 v27, v27, v125
    v_mfma_f32_16x16x32_bf16 v[156:159], a[252:255], a[164:167], v[156:159]
    v_fma_f32 v126, v126, s27, v21
    v_fma_f32 v127, v127, s27, v21
    v_fma_f32 v128, v128, s27, v22
    v_mfma_f32_16x16x32_bf16 v[156:159], a[224:227], a[168:171], v[156:159]
    v_exp_f32 v126, v126
    v_fma_f32 v129, v129, s27, v22
    v_mfma_f32_16x16x32_bf16 v[156:159], a[228:231], a[172:175], v[156:159]
    v_exp_f32 v127, v127
    v_add_f32 v27, v27, v126
    v_mfma_f32_16x16x32_bf16 v[156:159], a[192:195], a[176:179], v[156:159]
    buffer_load_dwordx4 v18, s[12:15], s22 offen offset:3072 lds
    v_add_f32 v27, v27, v127
    v_mfma_f32_16x16x32_bf16 v[156:159], a[196:199], a[180:183], v[156:159]
    v_exp_f32 v128, v128
    v_fma_f32 v130, v130, s27, v22
    v_mfma_f32_16x16x32_bf16 v[156:159], a[200:203], a[184:187], v[156:159]
    v_permlane32_swap_b32 v26, v27
    v_exp_f32 v129, v129
    v_mfma_f32_16x16x32_bf16 v[156:159], a[204:207], a[188:191], v[156:159]
    s_waitcnt lgkmcnt(15)
    v_add_f32 v26, v26, v27
    v_exp_f32 v130, v130
    v_mfma_f32_16x16x32_bf16 v[160:163], v[64:67], v[40:43], v[160:163]
    v_add_f32 v28, v28, v128
    v_fma_f32 v131, v131, s27, v22
    v_fma_f32 v132, v132, s27, v22
    v_mfma_f32_16x16x32_bf16 v[164:167], v[68:71], v[40:43], v[164:167]
    v_exp_f32 v131, v131
    v_add_f32 v28, v28, v129
    v_mfma_f32_16x16x32_bf16 v[168:171], v[72:75], v[40:43], v[168:171]
    v_exp_f32 v132, v132
    v_add_f32 v28, v28, v130
    v_mfma_f32_16x16x32_bf16 v[172:175], v[76:79], v[40:43], v[172:175]
    v_cvt_pk_bf16_f32 v40, v112, v113
    v_cvt_pk_bf16_f32 v41, v114, v115
    v_cvt_pk_bf16_f32 v42, v116, v117
    v_mfma_f32_16x16x32_bf16 v[176:179], v[64:67], v[44:47], v[176:179]
    v_cvt_pk_bf16_f32 v43, v118, v119
    v_add_f32 v28, v28, v131
    v_fma_f32 v133, v133, s27, v22
    v_mfma_f32_16x16x32_bf16 v[180:183], v[68:71], v[44:47], v[180:183]
    v_exp_f32 v133, v133
    v_add_f32 v28, v28, v132
    v_mfma_f32_16x16x32_bf16 v[184:187], v[72:75], v[44:47], v[184:187]
    v_add_f32 v28, v28, v133
    v_fma_f32 v134, v134, s27, v22
    v_fma_f32 v135, v135, s27, v22
    v_mfma_f32_16x16x32_bf16 v[188:191], v[76:79], v[44:47], v[188:191]
    v_exp_f32 v134, v134
    v_cvt_pk_bf16_f32 v44, v120, v121
    v_mfma_f32_16x16x32_bf16 v[192:195], v[64:67], v[48:51], v[192:195]
    v_exp_f32 v135, v135
    v_cvt_pk_bf16_f32 v45, v122, v123
    v_mfma_f32_16x16x32_bf16 v[196:199], v[68:71], v[48:51], v[196:199]
    v_cvt_pk_bf16_f32 v46, v124, v125
    v_cvt_pk_bf16_f32 v47, v126, v127
    v_add_f32 v28, v28, v134
    v_mfma_f32_16x16x32_bf16 v[200:203], v[72:75], v[48:51], v[200:203]
    s_barrier
    v_add_f32 v28, v28, v135
    v_mfma_f32_16x16x32_bf16 v[204:207], v[76:79], v[48:51], v[204:207]
    ds_read_b128 a[128:131], v8 offset:0
    v_cvt_pk_bf16_f32 v48, v128, v129
    v_cvt_pk_bf16_f32 v49, v130, v131
    v_mfma_f32_16x16x32_bf16 v[208:211], v[64:67], v[52:55], v[208:211]
    ds_read_b128 a[132:135], v9 offset:0
    v_cvt_pk_bf16_f32 v50, v132, v133
    v_cvt_pk_bf16_f32 v51, v134, v135
    v_mfma_f32_16x16x32_bf16 v[212:215], v[68:71], v[52:55], v[212:215]
    v_fma_f32 v136, v136, s27, v23
    v_fma_f32 v137, v137, s27, v23
    v_fma_f32 v138, v138, s27, v23
    v_mfma_f32_16x16x32_bf16 v[216:219], v[72:75], v[52:55], v[216:219]
    v_exp_f32 v136, v136
    v_fma_f32 v139, v139, s27, v23
    v_mfma_f32_16x16x32_bf16 v[220:223], v[76:79], v[52:55], v[220:223]
    v_exp_f32 v137, v137
    v_add_f32 v29, v29, v136
L_iw6:
    s_cbranch_execz L_iwdone
    v_mfma_f32_16x16x32_bf16 v[224:227], v[64:67], v[56:59], v[224:227]
    s_waitcnt vmcnt(12)
    ds_read_b64_tr_b16 a[64:65], v3 offset:16384
    ds_read_b64_tr_b16 a[66:67], v3 offset:18432
    v_cvt_pk_bf16_f32 v52, v136, v137
    v_mfma_f32_16x16x32_bf16 v[228:231], v[68:71], v[56:59], v[228:231]
    ds_read_b128 a[136:139], v10 offset:0
    v_exp_f32 v138, v138
    v_mfma_f32_16x16x32_bf16 v[232:235], v[72:75], v[56:59], v[232:235]
    ds_read_b64_tr_b16 a[68:69], v4 offset:16384
    ds_read_b64_tr_b16 a[70:71], v4 offset:18432
    v_add_f32 v29, v29, v137
    v_mfma_f32_16x16x32_bf16 v[236:239], v[76:79], v[56:59], v[236:239]
    v_exp_f32 v139, v139
    v_add_f32 v29, v29, v138
    v_mfma_f32_16x16x32_bf16 v[240:243], v[64:67], v[60:63], v[240:243]
    ds_read_b64_tr_b16 a[72:73], v5 offset:16384
    ds_read_b64_tr_b16 a[74:75], v5 offset:18432
    v_cvt_pk_bf16_f32 v53, v138, v139
    v_mfma_f32_16x16x32_bf16 v[244:247], v[68:71], v[60:63], v[244:247]
    ds_read_b128 a[140:143], v8 offset:1024
    v_add_f32 v29, v29, v139
    v_fma_f32 v140, v140, s27, v23
    v_mfma_f32_16x16x32_bf16 v[248:251], v[72:75], v[60:63], v[248:251]
    ds_read_b64_tr_b16 a[76:77], v6 offset:16384
    ds_read_b64_tr_b16 a[78:79], v6 offset:18432
    v_fma_f32 v141, v141, s27, v23
    v_mfma_f32_16x16x32_bf16 v[252:255], v[76:79], v[60:63], v[252:255]
    s_waitcnt lgkmcnt(10)
    v_exp_f32 v140, v140
    v_fma_f32 v142, v142, s27, v23
    v_mfma_f32_16x16x32_bf16 v[160:163], v[80:83], a[128:131], v[160:163]
    s_waitcnt vmcnt(8)
    ds_read_b64_tr_b16 a[80:81], v3 offset:20480
    ds_read_b64_tr_b16 a[82:83], v3 offset:22528
    v_add_f32 v29, v29, v140
    v_mfma_f32_16x16x32_bf16 v[164:167], v[84:87], a[128:131], v[164:167]
    ds_read_b128 a[144:147], v9 offset:1024
    v_exp_f32 v141, v141
    v_mfma_f32_16x16x32_bf16 v[168:171], v[88:91], a[128:131], v[168:171]
    ds_read_b64_tr_b16 a[84:85], v4 offset:20480
    ds_read_b64_tr_b16 a[86:87], v4 offset:22528
    v_cvt_pk_bf16_f32 v54, v140, v141
    v_mfma_f32_16x16x32_bf16 v[172:175], v[92:95], a[128:131], v[172:175]
    v_exp_f32 v142, v142
    v_add_f32 v29, v29, v141
    v_mfma_f32_16x16x32_bf16 v[160:163], a[0:3], a[132:135], v[160:163]
    ds_read_b64_tr_b16 a[88:89], v5 offset:20480
    ds_read_b64_tr_b16 a[90:91], v5 offset:22528
    v_add_f32 v29, v29, v142
    v_mfma_f32_16x16x32_bf16 v[164:167], a[4:7], a[132:135], v[164:167]
    ds_read_b128 a[148:151], v10 offset:1024
    ds_write_b128 v11, v[40:43] offset:0
    v_mfma_f32_16x16x32_bf16 v[168:171], a[8:11], a[132:135], v[168:171]
    ds_read_b64_tr_b16 a[92:93], v6 offset:20480
    ds_read_b64_tr_b16 a[94:95], v6 offset:22528
    v_fma_f32 v143, v143, s27, v23
    v_mfma_f32_16x16x32_bf16 v[172:175], a[12:15], a[132:135], v[172:175]
    s_waitcnt lgkmcnt(11)
    ds_write_b32 v33, v26 offset:3072
    v_fma_f32 v144, v144, s27, v24
    v_mfma_f32_16x16x32_bf16 v[160:163], a[16:19], a[136:139], v[160:163]
    s_waitcnt vmcnt(4)
    ds_read_b64_tr_b16 a[96:97], v3 offset:24576
    ds_read_b64_tr_b16 a[98:99], v3 offset:26624
    v_fma_f32 v145, v145, s27, v24
    v_mfma_f32_16x16x32_bf16 v[164:167], a[20:23], a[136:139], v[164:167]
    ds_write_b128 v11, v[44:47] offset:1024
    v_mfma_f32_16x16x32_bf16 v[168:171], a[24:27], a[136:139], v[168:171]
    ds_read_b64_tr_b16 a[100:101], v4 offset:24576
    ds_read_b64_tr_b16 a[102:103], v4 offset:26624
    v_mfma_f32_16x16x32_bf16 v[172:175], a[28:31], a[136:139], v[172:175]
    v_exp_f32 v143, v143
    v_fma_f32 v146, v146, s27, v24
    v_mfma_f32_16x16x32_bf16 v[176:179], v[80:83], a[140:143], v[176:179]
    ds_read_b64_tr_b16 a[104:105], v5 offset:24576
    ds_read_b64_tr_b16 a[106:107], v5 offset:26624
    v_cvt_pk_bf16_f32 v55, v142, v143
    v_mfma_f32_16x16x32_bf16 v[180:183], v[84:87], a[140:143], v[180:183]
    ds_write_b128 v11, v[48:51] offset:2048
    v_add_f32 v29, v29, v143
    v_mfma_f32_16x16x32_bf16 v[184:187], v[88:91], a[140:143], v[184:187]
    ds_read_b64_tr_b16 a[108:109], v6 offset:24576
    ds_read_b64_tr_b16 a[110:111], v6 offset:26624
    v_mfma_f32_16x16x32_bf16 v[188:191], v[92:95], a[140:143], v[188:191]
    s_waitcnt lgkmcnt(14)
    v_permlane32_swap_b32 v28, v29
    v_exp_f32 v144, v144
    v_mfma_f32_16x16x32_bf16 v[176:179], a[0:3], a[144:147], v[176:179]
    s_waitcnt vmcnt(0)
    ds_read_b64_tr_b16 a[112:113], v3 offset:28672
    ds_read_b64_tr_b16 a[114:115], v3 offset:30720
    v_add_f32 v28, v28, v29
    v_mfma_f32_16x16x32_bf16 v[180:183], a[4:7], a[144:147], v[180:183]
    ds_write_b128 v11, v[52:55] offset:3072
    v_add_f32 v30, v30, v144
    v_mfma_f32_16x16x32_bf16 v[184:187], a[8:11], a[144:147], v[184:187]
    s_waitcnt lgkmcnt(8)
    s_barrier
    v_fma_f32 v147, v147, s27, v24
    v_mfma_f32_16x16x32_bf16 v[188:191], a[12:15], a[144:147], v[188:191]
    ds_read_b64_tr_b16 a[116:117], v4 offset:28672
    ds_read_b64_tr_b16 a[118:119], v4 offset:30720
    v_mfma_f32_16x16x32_bf16 v[176:179], a[16:19], a[148:151], v[176:179]
    ds_read_b128 a[152:155], v12 offset:0
    ds_read_b128 a[156:159], v13 offset:0
    v_mfma_f32_16x16x32_bf16 v[180:183], a[20:23], a[148:151], v[180:183]
    ds_read_b64_tr_b16 a[120:121], v5 offset:28672
    ds_read_b64_tr_b16 a[122:123], v5 offset:30720
    v_mfma_f32_16x16x32_bf16 v[184:187], a[24:27], a[148:151], v[184:187]
    ds_read_b128 a[160:163], v14 offset:0
    ds_read_b128 v[112:115], v34 offset:3072
    v_mfma_f32_16x16x32_bf16 v[188:191], a[28:31], a[148:151], v[188:191]
    ds_read_b64_tr_b16 a[124:125], v6 offset:28672
    ds_read_b64_tr_b16 a[126:127], v6 offset:30720
    v_mfma_f32_16x16x32_bf16 v[160:163], a[64:67], v[40:43], v[160:163]
    ds_read_b128 v[116:119], v34 offset:3088
    ds_write_b32 v33, v28 offset:4096
    v_mfma_f32_16x16x32_bf16 v[164:167], a[68:71], v[40:43], v[164:167]
    v_exp_f32 v145, v145
    v_fma_f32 v148, v148, s27, v24
    v_mfma_f32_16x16x32_bf16 v[168:171], a[72:75], v[40:43], v[168:171]
    v_exp_f32 v146, v146
    v_cvt_pk_bf16_f32 v56, v144, v145
    v_mfma_f32_16x16x32_bf16 v[172:175], a[76:79], v[40:43], v[172:175]
    s_waitcnt lgkmcnt(9)
    v_exp_f32 v147, v147
    v_add_f32 v30, v30, v145
    v_mfma_f32_16x16x32_bf16 v[160:163], a[80:83], a[152:155], v[160:163]
    ds_read_b128 a[164:167], v12 offset:1024
    v_exp_f32 v148, v148
    v_mfma_f32_16x16x32_bf16 v[164:167], a[84:87], a[152:155], v[164:167]
    v_cvt_pk_bf16_f32 v57, v146, v147
    v_add_f32 v30, v30, v146
    v_fma_f32 v149, v149, s27, v24
    v_mfma_f32_16x16x32_bf16 v[168:171], a[88:91], a[152:155], v[168:171]
    v_exp_f32 v149, v149
    v_add_f32 v30, v30, v147
    v_mfma_f32_16x16x32_bf16 v[172:175], a[92:95], a[152:155], v[172:175]
    s_waitcnt lgkmcnt(3)
    v_cvt_pk_bf16_f32 v58, v148, v149
    v_add_f32 v30, v30, v148
    v_fma_f32 v150, v150, s27, v24
    v_mfma_f32_16x16x32_bf16 v[160:163], a[96:99], a[156:159], v[160:163]
    s_waitcnt lgkmcnt(2)
    ds_read_b128 a[168:171], v13 offset:1024
    v_add_f32 v112, v112, v116
    v_add_f32 v113, v113, v117
    v_mfma_f32_16x16x32_bf16 v[164:167], a[100:103], a[156:159], v[164:167]
    v_add_f32 v114, v114, v118
    v_add_f32 v115, v115, v119
    v_add_f32 v112, v112, v114
    v_mfma_f32_16x16x32_bf16 v[168:171], a[104:107], a[156:159], v[168:171]
    v_add_f32 v113, v113, v115
    v_add_f32 v112, v112, v113
    v_mov_b32 v38, v112
    v_mfma_f32_16x16x32_bf16 v[172:175], a[108:111], a[156:159], v[172:175]
    v_rcp_f32 v20, v112
    v_add_f32 v30, v30, v149
    v_mfma_f32_16x16x32_bf16 v[160:163], a[112:115], a[160:163], v[160:163]
    ds_read_b128 a[172:175], v14 offset:1024
    v_mov_b32 v21, v20
    v_fma_f32 v151, v151, s27, v24
    v_mfma_f32_16x16x32_bf16 v[164:167], a[116:119], a[160:163], v[164:167]
    v_exp_f32 v150, v150
    v_fma_f32 v152, v152, s27, v25
    v_mfma_f32_16x16x32_bf16 v[168:171], a[120:123], a[160:163], v[168:171]
    v_permlane32_swap_b32 v20, v21
    v_exp_f32 v151, v151
    v_mfma_f32_16x16x32_bf16 v[172:175], a[124:127], a[160:163], v[172:175]
    v_exp_f32 v152, v152
    v_cvt_pk_bf16_f32 v59, v150, v151
    v_mfma_f32_16x16x32_bf16 v[176:179], a[64:67], v[44:47], v[176:179]
    ds_read_b128 a[176:179], v8 offset:2048
    ds_write_b128 v11, v[56:59] offset:4096
    v_mfma_f32_16x16x32_bf16 v[180:183], a[68:71], v[44:47], v[180:183]
    v_add_f32 v30, v30, v150
    v_fma_f32 v153, v153, s27, v25
    v_fma_f32 v154, v154, s27, v25
    v_mfma_f32_16x16x32_bf16 v[184:187], a[72:75], v[44:47], v[184:187]
    v_mul_f32 v160, v20, v160
    v_mul_f32 v161, v20, v161
    v_mul_f32 v162, v20, v162
    v_mfma_f32_16x16x32_bf16 v[188:191], a[76:79], v[44:47], v[188:191]
    s_waitcnt lgkmcnt(3)
    v_mul_f32 v163, v20, v163
    v_mul_f32 v164, v20, v164
    v_mul_f32 v165, v20, v165
    v_mfma_f32_16x16x32_bf16 v[176:179], a[80:83], a[164:167], v[176:179]
    ds_read_b128 a[180:183], v9 offset:2048
    v_cvt_pk_bf16_f32 v160, v160, v161
    v_cvt_pk_bf16_f32 v161, v162, v163
    v_mfma_f32_16x16x32_bf16 v[180:183], a[84:87], a[164:167], v[180:183]
    ds_write_b64 v1, v[160:161] offset:8192
    v_mul_f32 v166, v20, v166
    v_mfma_f32_16x16x32_bf16 v[184:187], a[88:91], a[164:167], v[184:187]
    v_mul_f32 v167, v20, v167
    v_mul_f32 v168, v20, v168
    v_mul_f32 v169, v20, v169
    v_mfma_f32_16x16x32_bf16 v[188:191], a[92:95], a[164:167], v[188:191]
    v_cvt_pk_bf16_f32 v164, v164, v165
    v_cvt_pk_bf16_f32 v165, v166, v167
    v_mul_f32 v170, v20, v170
    v_mfma_f32_16x16x32_bf16 v[176:179], a[96:99], a[168:171], v[176:179]
    ds_read_b128 a[184:187], v10 offset:2048
    ds_write_b64 v2, v[164:165] offset:8192
    v_mfma_f32_16x16x32_bf16 v[180:183], a[100:103], a[168:171], v[180:183]
    v_mul_f32 v171, v20, v171
    v_mul_f32 v172, v20, v172
    v_mul_f32 v173, v20, v173
    v_mfma_f32_16x16x32_bf16 v[184:187], a[104:107], a[168:171], v[184:187]
    v_cvt_pk_bf16_f32 v168, v168, v169
    v_cvt_pk_bf16_f32 v169, v170, v171
    v_mul_f32 v174, v20, v174
    v_mfma_f32_16x16x32_bf16 v[188:191], a[108:111], a[168:171], v[188:191]
    s_waitcnt lgkmcnt(5)
    ds_write_b64 v35, v[168:169] offset:8192
    v_mul_f32 v175, v20, v175
    v_mfma_f32_16x16x32_bf16 v[176:179], a[112:115], a[172:175], v[176:179]
    ds_read_b128 a[188:191], v8 offset:3072
    v_cvt_pk_bf16_f32 v172, v172, v173
    v_cvt_pk_bf16_f32 v173, v174, v175
    v_mfma_f32_16x16x32_bf16 v[180:183], a[116:119], a[172:175], v[180:183]
    ds_write_b64 v39, v[172:173] offset:8192
    v_add_f32 v30, v30, v151
    v_mfma_f32_16x16x32_bf16 v[184:187], a[120:123], a[172:175], v[184:187]
    ds_read_b128 v[160:163], v11 offset:8192
    ds_read_b128 v[164:167], v11 offset:9216
    v_add_f32 v31, v31, v152
    v_mfma_f32_16x16x32_bf16 v[188:191], a[124:127], a[172:175], v[188:191]
    v_exp_f32 v153, v153
    v_fma_f32 v155, v155, s27, v25
    v_mfma_f32_16x16x32_bf16 v[192:195], v[80:83], a[176:179], v[192:195]
    ds_read_b128 a[192:195], v9 offset:3072
    v_exp_f32 v154, v154
    v_mfma_f32_16x16x32_bf16 v[196:199], v[84:87], a[176:179], v[196:199]
    v_exp_f32 v155, v155
    v_cvt_pk_bf16_f32 v60, v152, v153
    v_mfma_f32_16x16x32_bf16 v[200:203], v[88:91], a[176:179], v[200:203]
    v_mul_f32 v176, v21, v176
    v_mul_f32 v177, v21, v177
    v_mul_f32 v178, v21, v178
    v_mfma_f32_16x16x32_bf16 v[204:207], v[92:95], a[176:179], v[204:207]
    s_waitcnt lgkmcnt(9)
    v_mul_f32 v179, v21, v179
    v_mul_f32 v180, v21, v180
    v_mul_f32 v181, v21, v181
    v_mfma_f32_16x16x32_bf16 v[192:195], a[0:3], a[180:183], v[192:195]
    s_mov_b32 s32, 0
    ds_read_b128 a[196:199], v10 offset:3072
    v_cvt_pk_bf16_f32 v176, v176, v177
    v_cvt_pk_bf16_f32 v177, v178, v179
    v_mfma_f32_16x16x32_bf16 v[196:199], a[4:7], a[180:183], v[196:199]
    s_mov_b32 s33, 4096
    ds_write_b64 v1, v[176:177] offset:10240
    v_mul_f32 v182, v21, v182
    v_mfma_f32_16x16x32_bf16 v[200:203], a[8:11], a[180:183], v[200:203]
    s_waitcnt lgkmcnt(3)
    buffer_store_dwordx4 v[160:163], v37, s[16:19], s32 offen sc0 sc1
    v_mul_f32 v183, v21, v183
    v_mfma_f32_16x16x32_bf16 v[204:207], a[12:15], a[180:183], v[204:207]
    v_cvt_pk_bf16_f32 v180, v180, v181
    v_cvt_pk_bf16_f32 v181, v182, v183
    v_mul_f32 v184, v21, v184
    v_mfma_f32_16x16x32_bf16 v[192:195], a[16:19], a[184:187], v[192:195]
    ds_write_b64 v2, v[180:181] offset:10240
    v_mul_f32 v185, v21, v185
    v_mfma_f32_16x16x32_bf16 v[196:199], a[20:23], a[184:187], v[196:199]
    v_mul_f32 v186, v21, v186
    v_mul_f32 v187, v21, v187
    v_mul_f32 v188, v21, v188
    v_mfma_f32_16x16x32_bf16 v[200:203], a[24:27], a[184:187], v[200:203]
    buffer_store_dwordx4 v[164:167], v37, s[16:19], s33 offen sc0 sc1
    v_cvt_pk_bf16_f32 v184, v184, v185
    v_mfma_f32_16x16x32_bf16 v[204:207], a[28:31], a[184:187], v[204:207]
    v_cvt_pk_bf16_f32 v185, v186, v187
    v_mul_f32 v189, v21, v189
    v_mul_f32 v190, v21, v190
    v_mfma_f32_16x16x32_bf16 v[208:211], v[80:83], a[188:191], v[208:211]
    ds_write_b64 v35, v[184:185] offset:10240
    v_mul_f32 v191, v21, v191
    v_mfma_f32_16x16x32_bf16 v[212:215], v[84:87], a[188:191], v[212:215]
    v_cvt_pk_bf16_f32 v188, v188, v189
    v_cvt_pk_bf16_f32 v189, v190, v191
    v_cvt_pk_bf16_f32 v61, v154, v155
    v_mfma_f32_16x16x32_bf16 v[216:219], v[88:91], a[188:191], v[216:219]
    ds_write_b64 v39, v[188:189] offset:10240
    v_add_f32 v31, v31, v153
    v_mfma_f32_16x16x32_bf16 v[220:223], v[92:95], a[188:191], v[220:223]
    s_waitcnt lgkmcnt(4)
    ds_read_b128 v[176:179], v11 offset:10240
    ds_read_b128 v[180:183], v11 offset:11264
    v_add_f32 v31, v31, v154
    v_mfma_f32_16x16x32_bf16 v[208:211], a[0:3], a[192:195], v[208:211]
    v_add_f32 v31, v31, v155
    v_fma_f32 v156, v156, s27, v25
    v_fma_f32 v157, v157, s27, v25
    v_mfma_f32_16x16x32_bf16 v[212:215], a[4:7], a[192:195], v[212:215]
    v_exp_f32 v156, v156
    v_fma_f32 v158, v158, s27, v25
    v_mfma_f32_16x16x32_bf16 v[216:219], a[8:11], a[192:195], v[216:219]
    s_barrier
    v_add_f32 v31, v31, v156
    v_mfma_f32_16x16x32_bf16 v[220:223], a[12:15], a[192:195], v[220:223]
    ds_read_b128 a[200:203], v12 offset:2048
    ds_read_b128 a[204:207], v13 offset:2048
    v_fma_f32 v159, v159, s27, v25
    v_mfma_f32_16x16x32_bf16 v[208:211], a[16:19], a[196:199], v[208:211]
    ds_read_b128 a[208:211], v14 offset:2048
    v_mfma_f32_16x16x32_bf16 v[212:215], a[20:23], a[196:199], v[212:215]
    s_mov_b32 s34, 8192
    ds_read_b128 v[128:131], v34 offset:4096
    ds_read_b128 v[132:135], v34 offset:4112
    v_mfma_f32_16x16x32_bf16 v[216:219], a[24:27], a[196:199], v[216:219]
    s_mov_b32 s35, 12288
    v_exp_f32 v157, v157
    v_mfma_f32_16x16x32_bf16 v[220:223], a[28:31], a[196:199], v[220:223]
    s_waitcnt lgkmcnt(5)
    buffer_store_dwordx4 v[176:179], v37, s[16:19], s34 offen sc0 sc1
    v_mfma_f32_16x16x32_bf16 v[192:195], a[64:67], v[48:51], v[192:195]
    v_exp_f32 v158, v158
    v_mfma_f32_16x16x32_bf16 v[196:199], a[68:71], v[48:51], v[196:199]
    v_exp_f32 v159, v159
    v_mfma_f32_16x16x32_bf16 v[200:203], a[72:75], v[48:51], v[200:203]
    v_cvt_pk_bf16_f32 v62, v156, v157
    v_cvt_pk_bf16_f32 v63, v158, v159
    v_mfma_f32_16x16x32_bf16 v[204:207], a[76:79], v[48:51], v[204:207]
    s_waitcnt lgkmcnt(3)
    ds_write_b128 v11, v[60:63] offset:5120
    v_mfma_f32_16x16x32_bf16 v[192:195], a[80:83], a[200:203], v[192:195]
    ds_read_b128 a[212:215], v12 offset:3072
    v_add_f32 v31, v31, v157
    v_mfma_f32_16x16x32_bf16 v[196:199], a[84:87], a[200:203], v[196:199]
    s_waitcnt lgkmcnt(2)
    v_add_f32 v128, v128, v132
    v_add_f32 v129, v129, v133
    v_mfma_f32_16x16x32_bf16 v[200:203], a[88:91], a[200:203], v[200:203]
    v_add_f32 v130, v130, v134
    v_add_f32 v131, v131, v135
    v_mfma_f32_16x16x32_bf16 v[204:207], a[92:95], a[200:203], v[204:207]
    v_add_f32 v128, v128, v130
    v_add_f32 v129, v129, v131
    v_mfma_f32_16x16x32_bf16 v[192:195], a[96:99], a[204:207], v[192:195]
    ds_read_b128 a[216:219], v13 offset:3072
    v_add_f32 v128, v128, v129
    v_mfma_f32_16x16x32_bf16 v[196:199], a[100:103], a[204:207], v[196:199]
    v_max_f32 v38, v38, v128
    v_add_f32 v31, v31, v158
    v_mfma_f32_16x16x32_bf16 v[200:203], a[104:107], a[204:207], v[200:203]
    v_rcp_f32 v22, v128
    v_mfma_f32_16x16x32_bf16 v[204:207], a[108:111], a[204:207], v[204:207]
    v_mov_b32 v23, v22
    v_add_f32 v31, v31, v159
    v_mfma_f32_16x16x32_bf16 v[192:195], a[112:115], a[208:211], v[192:195]
    ds_read_b128 a[220:223], v14 offset:3072
    v_mfma_f32_16x16x32_bf16 v[196:199], a[116:119], a[208:211], v[196:199]
    v_permlane32_swap_b32 v30, v31
    v_permlane32_swap_b32 v22, v23
    v_mfma_f32_16x16x32_bf16 v[200:203], a[120:123], a[208:211], v[200:203]
    v_add_f32 v30, v30, v31
    v_mfma_f32_16x16x32_bf16 v[204:207], a[124:127], a[208:211], v[204:207]
    ds_write_b32 v33, v30 offset:5120
    v_mfma_f32_16x16x32_bf16 v[208:211], a[64:67], v[52:55], v[208:211]
    ds_read_b128 a[128:131], v8 offset:4096
    v_mfma_f32_16x16x32_bf16 v[212:215], a[68:71], v[52:55], v[212:215]
    buffer_store_dwordx4 v[180:183], v37, s[16:19], s35 offen sc0 sc1
    v_mfma_f32_16x16x32_bf16 v[216:219], a[72:75], v[52:55], v[216:219]
    v_mul_f32 v192, v22, v192
    v_mul_f32 v193, v22, v193
    v_mfma_f32_16x16x32_bf16 v[220:223], a[76:79], v[52:55], v[220:223]
    s_waitcnt lgkmcnt(3)
    v_mul_f32 v194, v22, v194
    v_mul_f32 v195, v22, v195
    v_mfma_f32_16x16x32_bf16 v[208:211], a[80:83], a[212:215], v[208:211]
    ds_read_b128 a[132:135], v9 offset:4096
    v_cvt_pk_bf16_f32 v192, v192, v193
    v_mfma_f32_16x16x32_bf16 v[212:215], a[84:87], a[212:215], v[212:215]
    v_cvt_pk_bf16_f32 v193, v194, v195
    v_mul_f32 v196, v22, v196
    v_mfma_f32_16x16x32_bf16 v[216:219], a[88:91], a[212:215], v[216:219]
    ds_write_b64 v1, v[192:193] offset:12288
    v_mfma_f32_16x16x32_bf16 v[220:223], a[92:95], a[212:215], v[220:223]
    v_mul_f32 v197, v22, v197
    v_mul_f32 v198, v22, v198
    v_mfma_f32_16x16x32_bf16 v[208:211], a[96:99], a[216:219], v[208:211]
    ds_read_b128 a[136:139], v10 offset:4096
    v_mul_f32 v199, v22, v199
    v_mfma_f32_16x16x32_bf16 v[212:215], a[100:103], a[216:219], v[212:215]
    v_cvt_pk_bf16_f32 v196, v196, v197
    v_cvt_pk_bf16_f32 v197, v198, v199
    v_mfma_f32_16x16x32_bf16 v[216:219], a[104:107], a[216:219], v[216:219]
    ds_write_b64 v2, v[196:197] offset:12288
    v_mfma_f32_16x16x32_bf16 v[220:223], a[108:111], a[216:219], v[220:223]
    s_waitcnt lgkmcnt(6)
    v_mul_f32 v200, v22, v200
    v_mul_f32 v201, v22, v201
    v_mfma_f32_16x16x32_bf16 v[208:211], a[112:115], a[220:223], v[208:211]
    ds_read_b128 a[140:143], v8 offset:5120
    v_mul_f32 v202, v22, v202
    v_mfma_f32_16x16x32_bf16 v[212:215], a[116:119], a[220:223], v[212:215]
    v_mul_f32 v203, v22, v203
    v_mul_f32 v204, v22, v204
    v_mfma_f32_16x16x32_bf16 v[216:219], a[120:123], a[220:223], v[216:219]
    v_cvt_pk_bf16_f32 v200, v200, v201
    v_cvt_pk_bf16_f32 v201, v202, v203
    v_mfma_f32_16x16x32_bf16 v[220:223], a[124:127], a[220:223], v[220:223]
    s_waitcnt lgkmcnt(4)
    ds_write_b64 v35, v[200:201] offset:12288
    v_mfma_f32_16x16x32_bf16 v[224:227], v[80:83], a[128:131], v[224:227]
    ds_read_b128 a[144:147], v9 offset:5120
    v_mul_f32 v205, v22, v205
    v_mfma_f32_16x16x32_bf16 v[228:231], v[84:87], a[128:131], v[228:231]
    v_mul_f32 v206, v22, v206
    v_mul_f32 v207, v22, v207
    v_mfma_f32_16x16x32_bf16 v[232:235], v[88:91], a[128:131], v[232:235]
    v_cvt_pk_bf16_f32 v204, v204, v205
    v_cvt_pk_bf16_f32 v205, v206, v207
    v_mfma_f32_16x16x32_bf16 v[236:239], v[92:95], a[128:131], v[236:239]
    ds_write_b64 v39, v[204:205] offset:12288
    v_mfma_f32_16x16x32_bf16 v[224:227], a[0:3], a[132:135], v[224:227]
    ds_read_b128 a[148:151], v10 offset:5120
    ds_read_b128 v[192:195], v11 offset:12288
    v_mfma_f32_16x16x32_bf16 v[228:231], a[4:7], a[132:135], v[228:231]
    ds_read_b128 v[196:199], v11 offset:13312
    v_mul_f32 v208, v23, v208
    v_mfma_f32_16x16x32_bf16 v[232:235], a[8:11], a[132:135], v[232:235]
    v_mul_f32 v209, v23, v209
    v_mul_f32 v210, v23, v210
    v_mfma_f32_16x16x32_bf16 v[236:239], a[12:15], a[132:135], v[236:239]
    s_waitcnt lgkmcnt(8)
    v_mul_f32 v211, v23, v211
    v_mul_f32 v212, v23, v212
    v_mfma_f32_16x16x32_bf16 v[224:227], a[16:19], a[136:139], v[224:227]
    v_cvt_pk_bf16_f32 v208, v208, v209
    v_cvt_pk_bf16_f32 v209, v210, v211
    v_mfma_f32_16x16x32_bf16 v[228:231], a[20:23], a[136:139], v[228:231]
    ds_write_b64 v1, v[208:209] offset:14336
    v_mfma_f32_16x16x32_bf16 v[232:235], a[24:27], a[136:139], v[232:235]
    s_mov_b32 s32, 16384
    v_mul_f32 v213, v23, v213
    v_mul_f32 v214, v23, v214
    v_mfma_f32_16x16x32_bf16 v[236:239], a[28:31], a[136:139], v[236:239]
    s_waitcnt lgkmcnt(7)
    v_mul_f32 v215, v23, v215
    v_mul_f32 v216, v23, v216
    v_mfma_f32_16x16x32_bf16 v[240:243], v[80:83], a[140:143], v[240:243]
    s_mov_b32 s33, 20480
    v_cvt_pk_bf16_f32 v212, v212, v213
    v_cvt_pk_bf16_f32 v213, v214, v215
    v_mfma_f32_16x16x32_bf16 v[244:247], v[84:87], a[140:143], v[244:247]
    s_waitcnt lgkmcnt(1)
    buffer_store_dwordx4 v[192:195], v37, s[16:19], s32 offen sc0 sc1
    v_mfma_f32_16x16x32_bf16 v[248:251], v[88:91], a[140:143], v[248:251]
    ds_write_b64 v2, v[212:213] offset:14336
    v_mfma_f32_16x16x32_bf16 v[252:255], v[92:95], a[140:143], v[252:255]
    v_mul_f32 v217, v23, v217
    v_mul_f32 v218, v23, v218
    v_mfma_f32_16x16x32_bf16 v[240:243], a[0:3], a[144:147], v[240:243]
    v_mul_f32 v219, v23, v219
    v_mul_f32 v220, v23, v220
    v_mfma_f32_16x16x32_bf16 v[244:247], a[4:7], a[144:147], v[244:247]
    buffer_store_dwordx4 v[196:199], v37, s[16:19], s33 offen sc0 sc1
    v_mfma_f32_16x16x32_bf16 v[248:251], a[8:11], a[144:147], v[248:251]
    s_barrier
    v_mfma_f32_16x16x32_bf16 v[252:255], a[12:15], a[144:147], v[252:255]
    ds_read_b128 a[152:155], v12 offset:4096
    ds_read_b128 a[156:159], v13 offset:4096
    v_mfma_f32_16x16x32_bf16 v[240:243], a[16:19], a[148:151], v[240:243]
    ds_read_b128 a[160:163], v14 offset:4096
    v_cvt_pk_bf16_f32 v216, v216, v217
    v_mfma_f32_16x16x32_bf16 v[244:247], a[20:23], a[148:151], v[244:247]
    ds_read_b128 v[144:147], v34 offset:5120
    ds_read_b128 v[148:151], v34 offset:5136
    v_mfma_f32_16x16x32_bf16 v[248:251], a[24:27], a[148:151], v[248:251]
    v_cvt_pk_bf16_f32 v217, v218, v219
    v_mul_f32 v221, v23, v221
    v_mfma_f32_16x16x32_bf16 v[252:255], a[28:31], a[148:151], v[252:255]
    ds_write_b64 v35, v[216:217] offset:14336
    v_mfma_f32_16x16x32_bf16 v[224:227], a[64:67], v[56:59], v[224:227]
    v_mul_f32 v222, v23, v222
    v_mul_f32 v223, v23, v223
    v_mfma_f32_16x16x32_bf16 v[228:231], a[68:71], v[56:59], v[228:231]
    v_cvt_pk_bf16_f32 v220, v220, v221
    v_cvt_pk_bf16_f32 v221, v222, v223
    v_mfma_f32_16x16x32_bf16 v[232:235], a[72:75], v[56:59], v[232:235]
    ds_write_b64 v39, v[220:221] offset:14336
    v_mfma_f32_16x16x32_bf16 v[236:239], a[76:79], v[56:59], v[236:239]
    s_waitcnt lgkmcnt(5)
    ds_read_b128 v[208:211], v11 offset:14336
    ds_read_b128 v[212:215], v11 offset:15360
    v_mfma_f32_16x16x32_bf16 v[224:227], a[80:83], a[152:155], v[224:227]
    ds_read_b128 a[164:167], v12 offset:5120
    v_mfma_f32_16x16x32_bf16 v[228:231], a[84:87], a[152:155], v[228:231]
    s_waitcnt lgkmcnt(5)
    v_add_f32 v144, v144, v148
    v_add_f32 v145, v145, v149
    v_mfma_f32_16x16x32_bf16 v[232:235], a[88:91], a[152:155], v[232:235]
    v_add_f32 v146, v146, v150
    v_add_f32 v147, v147, v151
    v_mfma_f32_16x16x32_bf16 v[236:239], a[92:95], a[152:155], v[236:239]
    v_add_f32 v144, v144, v146
    v_add_f32 v145, v145, v147
    v_mfma_f32_16x16x32_bf16 v[224:227], a[96:99], a[156:159], v[224:227]
    ds_read_b128 a[168:171], v13 offset:5120
    v_add_f32 v144, v144, v145
    v_mfma_f32_16x16x32_bf16 v[228:231], a[100:103], a[156:159], v[228:231]
    s_mov_b32 s34, 24576
    v_max_f32 v38, v38, v144
    v_mfma_f32_16x16x32_bf16 v[232:235], a[104:107], a[156:159], v[232:235]
    v_rcp_f32 v24, v144
    v_mfma_f32_16x16x32_bf16 v[236:239], a[108:111], a[156:159], v[236:239]
    v_mov_b32 v25, v24
    v_mfma_f32_16x16x32_bf16 v[224:227], a[112:115], a[160:163], v[224:227]
    ds_read_b128 a[172:175], v14 offset:5120
    v_mfma_f32_16x16x32_bf16 v[228:231], a[116:119], a[160:163], v[228:231]
    v_permlane32_swap_b32 v24, v25
    v_cmp_lt_f32 vcc, s28, v38
    v_mfma_f32_16x16x32_bf16 v[232:235], a[120:123], a[160:163], v[232:235]
    s_cbranch_vccnz L_fb
L_fbret:
    v_mfma_f32_16x16x32_bf16 v[236:239], a[124:127], a[160:163], v[236:239]
    s_waitcnt lgkmcnt(2)
    buffer_store_dwordx4 v[208:211], v37, s[16:19], s34 offen sc0 sc1
    s_mov_b32 s35, 28672
    v_mfma_f32_16x16x32_bf16 v[240:243], a[64:67], v[60:63], v[240:243]
    v_mfma_f32_16x16x32_bf16 v[244:247], a[68:71], v[60:63], v[244:247]
    v_mfma_f32_16x16x32_bf16 v[248:251], a[72:75], v[60:63], v[248:251]
    v_mul_f32 v224, v24, v224
    v_mul_f32 v225, v24, v225
    v_mfma_f32_16x16x32_bf16 v[252:255], a[76:79], v[60:63], v[252:255]
    buffer_store_dwordx4 v[212:215], v37, s[16:19], s35 offen sc0 sc1
    v_mfma_f32_16x16x32_bf16 v[240:243], a[80:83], a[164:167], v[240:243]
    v_mul_f32 v226, v24, v226
    v_mul_f32 v227, v24, v227
    v_mfma_f32_16x16x32_bf16 v[244:247], a[84:87], a[164:167], v[244:247]
    v_cvt_pk_bf16_f32 v224, v224, v225
    v_cvt_pk_bf16_f32 v225, v226, v227
    v_mfma_f32_16x16x32_bf16 v[248:251], a[88:91], a[164:167], v[248:251]
    ds_write_b64 v1, v[224:225] offset:8192
    v_mfma_f32_16x16x32_bf16 v[252:255], a[92:95], a[164:167], v[252:255]
    s_waitcnt lgkmcnt(1)
    v_mul_f32 v228, v24, v228
    v_mul_f32 v229, v24, v229
    v_mfma_f32_16x16x32_bf16 v[240:243], a[96:99], a[168:171], v[240:243]
    v_mul_f32 v230, v24, v230
    v_mul_f32 v231, v24, v231
    v_mfma_f32_16x16x32_bf16 v[244:247], a[100:103], a[168:171], v[244:247]
    v_cvt_pk_bf16_f32 v228, v228, v229
    v_cvt_pk_bf16_f32 v229, v230, v231
    v_mfma_f32_16x16x32_bf16 v[248:251], a[104:107], a[168:171], v[248:251]
    ds_write_b64 v2, v[228:229] offset:8192
    v_mfma_f32_16x16x32_bf16 v[252:255], a[108:111], a[168:171], v[252:255]
    v_mul_f32 v232, v24, v232
    v_mul_f32 v233, v24, v233
    v_mfma_f32_16x16x32_bf16 v[240:243], a[112:115], a[172:175], v[240:243]
    v_mul_f32 v234, v24, v234
    v_mul_f32 v235, v24, v235
    v_mfma_f32_16x16x32_bf16 v[244:247], a[116:119], a[172:175], v[244:247]
    v_cvt_pk_bf16_f32 v232, v232, v233
    v_cvt_pk_bf16_f32 v233, v234, v235
    v_mfma_f32_16x16x32_bf16 v[248:251], a[120:123], a[172:175], v[248:251]
    ds_write_b64 v35, v[232:233] offset:8192
    v_mfma_f32_16x16x32_bf16 v[252:255], a[124:127], a[172:175], v[252:255]
    v_mul_f32 v236, v24, v236
    v_mul_f32 v237, v24, v237
    v_mul_f32 v238, v24, v238
    v_mul_f32 v239, v24, v239
    v_cvt_pk_bf16_f32 v236, v236, v237
    v_cvt_pk_bf16_f32 v237, v238, v239
    ds_write_b64 v39, v[236:237] offset:8192
    ds_read_b128 v[224:227], v11 offset:8192
    ds_read_b128 v[228:231], v11 offset:9216
    v_pk_mul_f32 v[240:241], v[240:241], v[24:25] op_sel:[0,1] op_sel_hi:[1,1]
    v_pk_mul_f32 v[242:243], v[242:243], v[24:25] op_sel:[0,1] op_sel_hi:[1,1]
    v_cvt_pk_bf16_f32 v240, v240, v241
    v_cvt_pk_bf16_f32 v241, v242, v243
    ds_write_b64 v1, v[240:241] offset:10240
    v_pk_mul_f32 v[244:245], v[244:245], v[24:25] op_sel:[0,1] op_sel_hi:[1,1]
    v_pk_mul_f32 v[246:247], v[246:247], v[24:25] op_sel:[0,1] op_sel_hi:[1,1]
    v_cvt_pk_bf16_f32 v244, v244, v245
    v_cvt_pk_bf16_f32 v245, v246, v247
    s_mov_b32 s32, 32768
    ds_write_b64 v2, v[244:245] offset:10240
    v_pk_mul_f32 v[248:249], v[248:249], v[24:25] op_sel:[0,1] op_sel_hi:[1,1]
    v_pk_mul_f32 v[250:251], v[250:251], v[24:25] op_sel:[0,1] op_sel_hi:[1,1]
    s_waitcnt lgkmcnt(3)
    buffer_store_dwordx4 v[224:227], v37, s[16:19], s32 offen sc0 sc1
    s_mov_b32 s33, 36864
    v_cvt_pk_bf16_f32 v248, v248, v249
    v_cvt_pk_bf16_f32 v249, v250, v251
    ds_write_b64 v35, v[248:249] offset:10240
    v_pk_mul_f32 v[252:253], v[252:253], v[24:25] op_sel:[0,1] op_sel_hi:[1,1]
    v_pk_mul_f32 v[254:255], v[254:255], v[24:25] op_sel:[0,1] op_sel_hi:[1,1]
    s_waitcnt lgkmcnt(3)
    buffer_store_dwordx4 v[228:231], v37, s[16:19], s33 offen sc0 sc1
    v_cvt_pk_bf16_f32 v252, v252, v253
    v_cvt_pk_bf16_f32 v253, v254, v255
    ds_write_b64 v39, v[252:253] offset:10240
    ds_read_b128 v[240:243], v11 offset:10240
    ds_read_b128 v[244:247], v11 offset:11264
    s_mov_b32 s34, 40960
    s_waitcnt lgkmcnt(1)
    buffer_store_dwordx4 v[240:243], v37, s[16:19], s34 offen sc0 sc1
    s_mov_b32 s35, 45056
    s_waitcnt lgkmcnt(0)
    buffer_store_dwordx4 v[244:247], v37, s[16:19], s35 offen sc0 sc1
L_end:
    s_endpgm
L_fb:
    s_cmp_lg_u32 s30, 0
    s_cbranch_scc1 L_fbret
    s_waitcnt vmcnt(0) lgkmcnt(0)
    s_nop 15
    s_barrier
    v_and_b32 v19, 15, v36
    v_lshlrev_b32 v19, 9, v19
    v_lshrrev_b32 v32, 4, v36
    v_lshl_add_u32 v19, v32, 4, v19
    s_lshl_b32 s31, s20, 14
    s_mov_b32 s32, 0
    buffer_load_dwordx4 a[0:3], v19, s[4:7], s32 offen offset:0
    buffer_load_dwordx4 a[4:7], v19, s[4:7], s32 offen offset:64
    buffer_load_dwordx4 a[8:11], v19, s[4:7], s32 offen offset:128
    buffer_load_dwordx4 a[12:15], v19, s[4:7], s32 offen offset:192
    buffer_load_dwordx4 a[16:19], v19, s[4:7], s32 offen offset:256
    buffer_load_dwordx4 a[20:23], v19, s[4:7], s32 offen offset:320
    buffer_load_dwordx4 a[24:27], v19, s[4:7], s32 offen offset:384
    buffer_load_dwordx4 a[28:31], v19, s[4:7], s32 offen offset:448
    v_mov_b32 v26, 0xff800000
    v_mov_b32 v20, 0x7f800000
    s_mov_b32 s32, 8192
    buffer_load_dwordx4 a[32:35], v19, s[4:7], s32 offen offset:0
    buffer_load_dwordx4 a[36:39], v19, s[4:7], s32 offen offset:64
    buffer_load_dwordx4 a[40:43], v19, s[4:7], s32 offen offset:128
    buffer_load_dwordx4 a[44:47], v19, s[4:7], s32 offen offset:192
    buffer_load_dwordx4 a[48:51], v19, s[4:7], s32 offen offset:256
    buffer_load_dwordx4 a[52:55], v19, s[4:7], s32 offen offset:320
    buffer_load_dwordx4 a[56:59], v19, s[4:7], s32 offen offset:384
    buffer_load_dwordx4 a[60:63], v19, s[4:7], s32 offen offset:448
    v_mov_b32 v27, 0xff800000
    v_mov_b32 v21, 0x7f800000
    s_mov_b32 s32, 16384
    buffer_load_dwordx4 a[64:67], v19, s[4:7], s32 offen offset:0
    buffer_load_dwordx4 a[68:71], v19, s[4:7], s32 offen offset:64
    buffer_load_dwordx4 a[72:75], v19, s[4:7], s32 offen offset:128
    buffer_load_dwordx4 a[76:79], v19, s[4:7], s32 offen offset:192
    buffer_load_dwordx4 a[80:83], v19, s[4:7], s32 offen offset:256
    buffer_load_dwordx4 a[84:87], v19, s[4:7], s32 offen offset:320
    buffer_load_dwordx4 a[88:91], v19, s[4:7], s32 offen offset:384
    buffer_load_dwordx4 a[92:95], v19, s[4:7], s32 offen offset:448
    v_mov_b32 v28, 0xff800000
    v_mov_b32 v22, 0x7f800000
    s_mov_b32 s32, 24576
    buffer_load_dwordx4 a[96:99], v19, s[4:7], s32 offen offset:0
    buffer_load_dwordx4 a[100:103], v19, s[4:7], s32 offen offset:64
    buffer_load_dwordx4 a[104:107], v19, s[4:7], s32 offen offset:128
    buffer_load_dwordx4 a[108:111], v19, s[4:7], s32 offen offset:192
    buffer_load_dwordx4 a[112:115], v19, s[4:7], s32 offen offset:256
    buffer_load_dwordx4 a[116:119], v19, s[4:7], s32 offen offset:320
    buffer_load_dwordx4 a[120:123], v19, s[4:7], s32 offen offset:384
    buffer_load_dwordx4 a[124:127], v19, s[4:7], s32 offen offset:448
    v_mov_b32 v29, 0xff800000
    v_mov_b32 v23, 0x7f800000
    s_mov_b32 s32, 32768
    buffer_load_dwordx4 a[128:131], v19, s[4:7], s32 offen offset:0
    buffer_load_dwordx4 a[132:135], v19, s[4:7], s32 offen offset:64
    buffer_load_dwordx4 a[136:139], v19, s[4:7], s32 offen offset:128
    buffer_load_dwordx4 a[140:143], v19, s[4:7], s32 offen offset:192
    buffer_load_dwordx4 a[144:147], v19, s[4:7], s32 offen offset:256
    buffer_load_dwordx4 a[148:151], v19, s[4:7], s32 offen offset:320
    buffer_load_dwordx4 a[152:155], v19, s[4:7], s32 offen offset:384
    buffer_load_dwordx4 a[156:159], v19, s[4:7], s32 offen offset:448
    v_mov_b32 v30, 0xff800000
    v_mov_b32 v24, 0x7f800000
    s_mov_b32 s32, 40960
    buffer_load_dwordx4 a[160:163], v19, s[4:7], s32 offen offset:0
    buffer_load_dwordx4 a[164:167], v19, s[4:7], s32 offen offset:64
    buffer_load_dwordx4 a[168:171], v19, s[4:7], s32 offen offset:128
    buffer_load_dwordx4 a[172:175], v19, s[4:7], s32 offen offset:192
    buffer_load_dwordx4 a[176:179], v19, s[4:7], s32 offen offset:256
    buffer_load_dwordx4 a[180:183], v19, s[4:7], s32 offen offset:320
    buffer_load_dwordx4 a[184:187], v19, s[4:7], s32 offen offset:384
    buffer_load_dwordx4 a[188:191], v19, s[4:7], s32 offen offset:448
    v_mov_b32 v31, 0xff800000
    v_mov_b32 v25, 0x7f800000
    s_waitcnt vmcnt(0) lgkmcnt(0)
L_fbloop:
    s_add_u32 s32, s31, 8192
    buffer_load_dwordx4 a[192:195], v19, s[8:11], s31 offen offset:0
    buffer_load_dwordx4 a[196:199], v19, s[8:11], s32 offen offset:0
    buffer_load_dwordx4 a[200:203], v19, s[8:11], s31 offen offset:64
    buffer_load_dwordx4 a[204:207], v19, s[8:11], s32 offen offset:64
    buffer_load_dwordx4 a[208:211], v19, s[8:11], s31 offen offset:128
    buffer_load_dwordx4 a[212:215], v19, s[8:11], s32 offen offset:128
    buffer_load_dwordx4 a[216:219], v19, s[8:11], s31 offen offset:192
    buffer_load_dwordx4 a[220:223], v19, s[8:11], s32 offen offset:192
    buffer_load_dwordx4 a[224:227], v19, s[8:11], s31 offen offset:256
    buffer_load_dwordx4 a[228:231], v19, s[8:11], s32 offen offset:256
    buffer_load_dwordx4 a[232:235], v19, s[8:11], s31 offen offset:320
    buffer_load_dwordx4 a[236:239], v19, s[8:11], s32 offen offset:320
    buffer_load_dwordx4 a[240:243], v19, s[8:11], s31 offen offset:384
    buffer_load_dwordx4 a[244:247], v19, s[8:11], s32 offen offset:384
    buffer_load_dwordx4 a[248:251], v19, s[8:11], s31 offen offset:448
    buffer_load_dwordx4 a[252:255], v19, s[8:11], s32 offen offset:448
    s_waitcnt vmcnt(15)
    v_mfma_f32_16x16x32_bf16 v[64:67], a[192:195], a[0:3], 0
    v_mfma_f32_16x16x32_bf16 v[72:75], a[192:195], a[32:35], 0
    v_mfma_f32_16x16x32_bf16 v[80:83], a[192:195], a[64:67], 0
    v_mfma_f32_16x16x32_bf16 v[88:91], a[192:195], a[96:99], 0
    v_mfma_f32_16x16x32_bf16 v[96:99], a[192:195], a[128:131], 0
    v_mfma_f32_16x16x32_bf16 v[104:107], a[192:195], a[160:163], 0
    s_waitcnt vmcnt(14)
    v_mfma_f32_16x16x32_bf16 v[68:71], a[196:199], a[0:3], 0
    v_mfma_f32_16x16x32_bf16 v[76:79], a[196:199], a[32:35], 0
    v_mfma_f32_16x16x32_bf16 v[84:87], a[196:199], a[64:67], 0
    v_mfma_f32_16x16x32_bf16 v[92:95], a[196:199], a[96:99], 0
    v_mfma_f32_16x16x32_bf16 v[100:103], a[196:199], a[128:131], 0
    v_mfma_f32_16x16x32_bf16 v[108:111], a[196:199], a[160:163], 0
    s_waitcnt vmcnt(13)
    v_mfma_f32_16x16x32_bf16 v[64:67], a[200:203], a[4:7], v[64:67]
    v_mfma_f32_16x16x32_bf16 v[72:75], a[200:203], a[36:39], v[72:75]
    v_mfma_f32_16x16x32_bf16 v[80:83], a[200:203], a[68:71], v[80:83]
    v_mfma_f32_16x16x32_bf16 v[88:91], a[200:203], a[100:103], v[88:91]
    v_mfma_f32_16x16x32_bf16 v[96:99], a[200:203], a[132:135], v[96:99]
    v_mfma_f32_16x16x32_bf16 v[104:107], a[200:203], a[164:167], v[104:107]
    s_waitcnt vmcnt(12)
    v_mfma_f32_16x16x32_bf16 v[68:71], a[204:207], a[4:7], v[68:71]
    v_mfma_f32_16x16x32_bf16 v[76:79], a[204:207], a[36:39], v[76:79]
    v_mfma_f32_16x16x32_bf16 v[84:87], a[204:207], a[68:71], v[84:87]
    v_mfma_f32_16x16x32_bf16 v[92:95], a[204:207], a[100:103], v[92:95]
    v_mfma_f32_16x16x32_bf16 v[100:103], a[204:207], a[132:135], v[100:103]
    v_mfma_f32_16x16x32_bf16 v[108:111], a[204:207], a[164:167], v[108:111]
    s_waitcnt vmcnt(11)
    v_mfma_f32_16x16x32_bf16 v[64:67], a[208:211], a[8:11], v[64:67]
    v_mfma_f32_16x16x32_bf16 v[72:75], a[208:211], a[40:43], v[72:75]
    v_mfma_f32_16x16x32_bf16 v[80:83], a[208:211], a[72:75], v[80:83]
    v_mfma_f32_16x16x32_bf16 v[88:91], a[208:211], a[104:107], v[88:91]
    v_mfma_f32_16x16x32_bf16 v[96:99], a[208:211], a[136:139], v[96:99]
    v_mfma_f32_16x16x32_bf16 v[104:107], a[208:211], a[168:171], v[104:107]
    s_waitcnt vmcnt(10)
    v_mfma_f32_16x16x32_bf16 v[68:71], a[212:215], a[8:11], v[68:71]
    v_mfma_f32_16x16x32_bf16 v[76:79], a[212:215], a[40:43], v[76:79]
    v_mfma_f32_16x16x32_bf16 v[84:87], a[212:215], a[72:75], v[84:87]
    v_mfma_f32_16x16x32_bf16 v[92:95], a[212:215], a[104:107], v[92:95]
    v_mfma_f32_16x16x32_bf16 v[100:103], a[212:215], a[136:139], v[100:103]
    v_mfma_f32_16x16x32_bf16 v[108:111], a[212:215], a[168:171], v[108:111]
    s_waitcnt vmcnt(9)
    v_mfma_f32_16x16x32_bf16 v[64:67], a[216:219], a[12:15], v[64:67]
    v_mfma_f32_16x16x32_bf16 v[72:75], a[216:219], a[44:47], v[72:75]
    v_mfma_f32_16x16x32_bf16 v[80:83], a[216:219], a[76:79], v[80:83]
    v_mfma_f32_16x16x32_bf16 v[88:91], a[216:219], a[108:111], v[88:91]
    v_mfma_f32_16x16x32_bf16 v[96:99], a[216:219], a[140:143], v[96:99]
    v_mfma_f32_16x16x32_bf16 v[104:107], a[216:219], a[172:175], v[104:107]
    s_waitcnt vmcnt(8)
    v_mfma_f32_16x16x32_bf16 v[68:71], a[220:223], a[12:15], v[68:71]
    v_mfma_f32_16x16x32_bf16 v[76:79], a[220:223], a[44:47], v[76:79]
    v_mfma_f32_16x16x32_bf16 v[84:87], a[220:223], a[76:79], v[84:87]
    v_mfma_f32_16x16x32_bf16 v[92:95], a[220:223], a[108:111], v[92:95]
    v_mfma_f32_16x16x32_bf16 v[100:103], a[220:223], a[140:143], v[100:103]
    v_mfma_f32_16x16x32_bf16 v[108:111], a[220:223], a[172:175], v[108:111]
    s_waitcnt vmcnt(7)
    v_mfma_f32_16x16x32_bf16 v[64:67], a[224:227], a[16:19], v[64:67]
    v_mfma_f32_16x16x32_bf16 v[72:75], a[224:227], a[48:51], v[72:75]
    v_mfma_f32_16x16x32_bf16 v[80:83], a[224:227], a[80:83], v[80:83]
    v_mfma_f32_16x16x32_bf16 v[88:91], a[224:227], a[112:115], v[88:91]
    v_mfma_f32_16x16x32_bf16 v[96:99], a[224:227], a[144:147], v[96:99]
    v_mfma_f32_16x16x32_bf16 v[104:107], a[224:227], a[176:179], v[104:107]
    s_waitcnt vmcnt(6)
    v_mfma_f32_16x16x32_bf16 v[68:71], a[228:231], a[16:19], v[68:71]
    v_mfma_f32_16x16x32_bf16 v[76:79], a[228:231], a[48:51], v[76:79]
    v_mfma_f32_16x16x32_bf16 v[84:87], a[228:231], a[80:83], v[84:87]
    v_mfma_f32_16x16x32_bf16 v[92:95], a[228:231], a[112:115], v[92:95]
    v_mfma_f32_16x16x32_bf16 v[100:103], a[228:231], a[144:147], v[100:103]
    v_mfma_f32_16x16x32_bf16 v[108:111], a[228:231], a[176:179], v[108:111]
    s_waitcnt vmcnt(5)
    v_mfma_f32_16x16x32_bf16 v[64:67], a[232:235], a[20:23], v[64:67]
    v_mfma_f32_16x16x32_bf16 v[72:75], a[232:235], a[52:55], v[72:75]
    v_mfma_f32_16x16x32_bf16 v[80:83], a[232:235], a[84:87], v[80:83]
    v_mfma_f32_16x16x32_bf16 v[88:91], a[232:235], a[116:119], v[88:91]
    v_mfma_f32_16x16x32_bf16 v[96:99], a[232:235], a[148:151], v[96:99]
    v_mfma_f32_16x16x32_bf16 v[104:107], a[232:235], a[180:183], v[104:107]
    s_waitcnt vmcnt(4)
    v_mfma_f32_16x16x32_bf16 v[68:71], a[236:239], a[20:23], v[68:71]
    v_mfma_f32_16x16x32_bf16 v[76:79], a[236:239], a[52:55], v[76:79]
    v_mfma_f32_16x16x32_bf16 v[84:87], a[236:239], a[84:87], v[84:87]
    v_mfma_f32_16x16x32_bf16 v[92:95], a[236:239], a[116:119], v[92:95]
    v_mfma_f32_16x16x32_bf16 v[100:103], a[236:239], a[148:151], v[100:103]
    v_mfma_f32_16x16x32_bf16 v[108:111], a[236:239], a[180:183], v[108:111]
    s_waitcnt vmcnt(3)
    v_mfma_f32_16x16x32_bf16 v[64:67], a[240:243], a[24:27], v[64:67]
    v_mfma_f32_16x16x32_bf16 v[72:75], a[240:243], a[56:59], v[72:75]
    v_mfma_f32_16x16x32_bf16 v[80:83], a[240:243], a[88:91], v[80:83]
    v_mfma_f32_16x16x32_bf16 v[88:91], a[240:243], a[120:123], v[88:91]
    v_mfma_f32_16x16x32_bf16 v[96:99], a[240:243], a[152:155], v[96:99]
    v_mfma_f32_16x16x32_bf16 v[104:107], a[240:243], a[184:187], v[104:107]
    s_waitcnt vmcnt(2)
    v_mfma_f32_16x16x32_bf16 v[68:71], a[244:247], a[24:27], v[68:71]
    v_mfma_f32_16x16x32_bf16 v[76:79], a[244:247], a[56:59], v[76:79]
    v_mfma_f32_16x16x32_bf16 v[84:87], a[244:247], a[88:91], v[84:87]
    v_mfma_f32_16x16x32_bf16 v[92:95], a[244:247], a[120:123], v[92:95]
    v_mfma_f32_16x16x32_bf16 v[100:103], a[244:247], a[152:155], v[100:103]
    v_mfma_f32_16x16x32_bf16 v[108:111], a[244:247], a[184:187], v[108:111]
    s_waitcnt vmcnt(1)
    v_mfma_f32_16x16x32_bf16 v[64:67], a[248:251], a[28:31], v[64:67]
    v_mfma_f32_16x16x32_bf16 v[72:75], a[248:251], a[60:63], v[72:75]
    v_mfma_f32_16x16x32_bf16 v[80:83], a[248:251], a[92:95], v[80:83]
    v_mfma_f32_16x16x32_bf16 v[88:91], a[248:251], a[124:127], v[88:91]
    v_mfma_f32_16x16x32_bf16 v[96:99], a[248:251], a[156:159], v[96:99]
    v_mfma_f32_16x16x32_bf16 v[104:107], a[248:251], a[188:191], v[104:107]
    s_waitcnt vmcnt(0)
    v_mfma_f32_16x16x32_bf16 v[68:71], a[252:255], a[28:31], v[68:71]
    v_mfma_f32_16x16x32_bf16 v[76:79], a[252:255], a[60:63], v[76:79]
    v_mfma_f32_16x16x32_bf16 v[84:87], a[252:255], a[92:95], v[84:87]
    v_mfma_f32_16x16x32_bf16 v[92:95], a[252:255], a[124:127], v[92:95]
    v_mfma_f32_16x16x32_bf16 v[100:103], a[252:255], a[156:159], v[100:103]
    v_mfma_f32_16x16x32_bf16 v[108:111], a[252:255], a[188:191], v[108:111]
    v_max3_f32 v26, v26, v64, v65
    v_max3_f32 v27, v27, v72, v73
    v_max3_f32 v26, v26, v66, v67
    v_max3_f32 v27, v27, v74, v75
    v_max3_f32 v26, v26, v68, v69
    v_max3_f32 v27, v27, v76, v77
    v_max3_f32 v26, v26, v70, v71
    v_max3_f32 v27, v27, v78, v79
    v_max3_f32 v28, v28, v80, v81
    v_max3_f32 v29, v29, v88, v89
    v_max3_f32 v28, v28, v82, v83
    v_max3_f32 v29, v29, v90, v91
    v_max3_f32 v28, v28, v84, v85
    v_max3_f32 v29, v29, v92, v93
    v_max3_f32 v28, v28, v86, v87
    v_max3_f32 v29, v29, v94, v95
    v_max3_f32 v30, v30, v96, v97
    v_max3_f32 v31, v31, v104, v105
    v_max3_f32 v30, v30, v98, v99
    v_max3_f32 v31, v31, v106, v107
    v_max3_f32 v30, v30, v100, v101
    v_max3_f32 v31, v31, v108, v109
    v_max3_f32 v30, v30, v102, v103
    v_max3_f32 v31, v31, v110, v111
    s_add_u32 s31, s31, 65536
    s_cmp_lt_u32 s31, 524288
    s_cbranch_scc1 L_fbloop
    v_permlane32_swap_b32 v26, v27
    v_max_f32 v26, v26, v27
    ds_write_b32 v33, v26 offset:0
    v_permlane32_swap_b32 v28, v29
    v_max_f32 v28, v28, v29
    ds_write_b32 v33, v28 offset:1024
    v_permlane32_swap_b32 v30, v31
    v_max_f32 v30, v30, v31
    ds_write_b32 v33, v30 offset:2048
    s_waitcnt lgkmcnt(0)
    s_barrier
    ds_read_b128 v[40:43], v34 offset:0
    ds_read_b128 v[44:47], v34 offset:16
    ds_read_b128 v[48:51], v34 offset:1024
    ds_read_b128 v[52:55], v34 offset:1040
    ds_read_b128 v[56:59], v34 offset:2048
    ds_read_b128 v[60:63], v34 offset:2064
    s_waitcnt lgkmcnt(5)
    v_max3_f32 v40, v40, v41, v42
    s_waitcnt lgkmcnt(4)
    v_max3_f32 v40, v40, v43, v44
    v_max3_f32 v40, v40, v45, v46
    v_max_f32 v40, v40, v47
    v_mul_f32 v40, s29, v40
    v_mov_b32 v41, v40
    s_nop 1
    v_permlane32_swap_b32 v40, v41
    v_min_f32 v20, v20, v40
    v_min_f32 v21, v21, v41
    s_waitcnt lgkmcnt(3)
    v_max3_f32 v48, v48, v49, v50
    s_waitcnt lgkmcnt(2)
    v_max3_f32 v48, v48, v51, v52
    v_max3_f32 v48, v48, v53, v54
    v_max_f32 v48, v48, v55
    v_mul_f32 v48, s29, v48
    v_mov_b32 v49, v48
    s_nop 1
    v_permlane32_swap_b32 v48, v49
    v_min_f32 v22, v22, v48
    v_min_f32 v23, v23, v49
    s_waitcnt lgkmcnt(1)
    v_max3_f32 v56, v56, v57, v58
    s_waitcnt lgkmcnt(0)
    v_max3_f32 v56, v56, v59, v60
    v_max3_f32 v56, v56, v61, v62
    v_max_f32 v56, v56, v63
    v_mul_f32 v56, s29, v56
    v_mov_b32 v57, v56
    s_nop 1
    v_permlane32_swap_b32 v56, v57
    v_min_f32 v24, v24, v56
    v_min_f32 v25, v25, v57
    s_mov_b32 s30, 1
    s_waitcnt vmcnt(0) lgkmcnt(0)
    s_barrier
    s_branch L_restart
L_codeend:
.section .rodata,"a"
.p2align 6
.amdhsa_kernel standalone__gqa_softmax__near_ridge_kernel
  .amdhsa_next_free_vgpr 512
  .amdhsa_next_free_sgpr 102
  .amdhsa_accum_offset 256
  .amdhsa_group_segment_fixed_size 0
  .amdhsa_kernarg_size 48
  .amdhsa_user_sgpr_count 2
  .amdhsa_user_sgpr_kernarg_segment_ptr 1
  .amdhsa_system_sgpr_workgroup_id_x 1
.end_amdhsa_kernel
```
